```python
import torch

def _softmax(x, axis=-1):
    return torch.softmax(x, dim=axis)
def _gelu(x):
    return torch.nn.functional.gelu(x, approximate="tanh")
def _silu(x):
    return torch.nn.functional.silu(x)
def _sigmoid(x):
    return torch.sigmoid(x)
def _layernorm(x, axis=-1, eps=1e-5):
    m = x.mean(dim=axis, keepdim=True)
    v = x.var(dim=axis, keepdim=True, unbiased=False)
    return (x - m) / torch.sqrt(v + eps)
def _scatter_add(tgt, idx, src, axis=0):
    return tgt.clone().index_add_(axis, idx, src)
def _segment_sum(src, seg, n):
    out = torch.zeros((n,) + src.shape[1:], dtype=src.dtype)
    return out.index_add_(0, seg, src)
def _pad(x, pw):
    flat = tuple(v for pair in reversed(pw) for v in pair)
    return torch.nn.functional.pad(x, flat)

kernel_name = 'recurrent_scan__spectral_fnet__glu_gated_reglu__prompt'

def setup_inputs():

    _w = (lambda a: (lambda t: t.to(torch.bfloat16) if t.is_floating_point() else t)(torch.as_tensor(a)))
    def _A_setup():
        B, S, D = 1, 2048, 512
        ns = torch.arange(S)[:, None] * torch.arange(S)[None, :]
        nd = torch.arange(D)[:, None] * torch.arange(D)[None, :]
        Ws_re = torch.cos(-2.0 * torch.pi * ns / S).to(float)
        Ws_im = torch.sin(-2.0 * torch.pi * ns / S).to(float)
        Wd_re = torch.cos(-2.0 * torch.pi * nd / D).to(float)
        Wd_im = torch.sin(-2.0 * torch.pi * nd / D).to(float)
        return {
            "x": _w((lambda *s: torch.randn(*s, dtype=torch.bfloat16) * 0.05)(B, S, D)),
            "dft_seq_re": _w(Ws_re),
            "dft_seq_im": _w(Ws_im),
            "dft_hid_re": _w(Wd_re),
            "dft_hid_im": _w(Wd_im),
        }
    _A_in = _A_setup()

    def _B_setup():
        B, S, D, F = 1, 2048, 512, 1792
        return {
            "x": _w((lambda *s: torch.randn(*s, dtype=torch.bfloat16) * 0.05)(B, S, D)),
            "W_gate": _w((lambda *s: torch.randn(*s, dtype=torch.bfloat16) * 0.05)(D, F) * (2.0 / D) ** 0.5),
            "W_up": _w((lambda *s: torch.randn(*s, dtype=torch.bfloat16) * 0.05)(D, F) * (2.0 / D) ** 0.5),
            "W_down": _w((lambda *s: torch.randn(*s, dtype=torch.bfloat16) * 0.05)(F, D) * (1.0 / F) ** 0.5),
        }
    _B_in = _B_setup()

    return {
        "A_x": _A_in["x"],
        "A_dft_seq_re": _A_in["dft_seq_re"],
        "A_dft_seq_im": _A_in["dft_seq_im"],
        "A_dft_hid_re": _A_in["dft_hid_re"],
        "A_dft_hid_im": _A_in["dft_hid_im"],
        "B_x": _B_in["x"],
        "B_W_gate": _B_in["W_gate"],
        "B_W_up": _B_in["W_up"],
        "B_W_down": _B_in["W_down"],
    }

def reference(A_x, A_dft_seq_re, A_dft_seq_im, A_dft_hid_re, A_dft_hid_im, B_x, B_W_gate, B_W_up, B_W_down):
    def _A_ref(x, dft_seq_re, dft_seq_im, dft_hid_re, dft_hid_im):
        a = torch.einsum("bsd,ed->bse", x, dft_hid_re)
        b = torch.einsum("bsd,ed->bse", x, dft_hid_im)
        y = torch.einsum("ts,bse->bte", dft_seq_re, a) - torch.einsum("ts,bse->bte", dft_seq_im, b)
        return y

    def _B_ref(x, W_gate, W_up, W_down):
        gate = torch.einsum("bsd,df->bsf", x, W_gate)
        up = torch.einsum("bsd,df->bsf", x, W_up)
        gate = gate * (lambda x, dt: x.to(dt))(gate > 0, gate.dtype)
        h = gate * up
        return torch.einsum("bsf,fd->bsd", h, W_down)

    x = A_x
    xn = _layernorm(x, axis=-1)
    s = _A_ref(xn, A_dft_seq_re, A_dft_seq_im, A_dft_hid_re, A_dft_hid_im)
    g = _silu(_B_ref(xn, B_W_gate, B_W_up, B_W_down))
    return x + s * g
```

```asm
; @launch kernel=recurrent_scan__spectral_fnet__glu_gated_reglu__prompt_kernel grid=(256,1,1) block=(512,1,1) lds=163840
; @launch kernel=fnet_glu_combine_kernel grid=(256,1,1) block=(256,1,1) lds=83968
.amdgcn_target "amdgcn-amd-amdhsa--gfx950"
.text
    .p2align 8
    .globl recurrent_scan__spectral_fnet__glu_gated_reglu__prompt_kernel
    .type recurrent_scan__spectral_fnet__glu_gated_reglu__prompt_kernel,@function
recurrent_scan__spectral_fnet__glu_gated_reglu__prompt_kernel:
    s_cmp_ge_u32 s2, 256
    s_cbranch_scc1 K1_END
    s_load_dwordx2 s[16:17], s[0:1], 0
    s_load_dwordx8 s[20:27], s[0:1], 16
    s_load_dwordx8 s[28:35], s[0:1], 48
    s_load_dwordx2 s[18:19], s[0:1], 8
    s_load_dwordx2 s[66:67], s[0:1], 88
    v_and_b32 v1, 63, v0
    v_lshrrev_b32 v2, 6, v0
    s_nop 0
    v_readfirstlane_b32 s3, v2
    v_lshrrev_b32 v2, 4, v1
    v_and_b32 v3, 15, v1
    v_and_b32 v4, 31, v1
    v_lshrrev_b32 v5, 5, v1
    s_and_b32 s70, s3, 3
    s_mov_b32 s60, 0xffff0000
    s_mov_b32 s61, 0x3b000000
    v_mov_b32 v39, 0x3727c5ac
    v_mov_b32 v38, 0x3f803f80
    s_cmp_ge_u32 s2, 224
    s_cbranch_scc1 K1_STAGE1
    s_and_b32 s4, s2, 7
    s_lshr_b32 s5, s2, 3
    s_and_b32 s6, s4, 3
    s_lshl_b32 s6, s6, 2
    s_and_b32 s7, s5, 3
    s_add_u32 s6, s6, s7
    s_lshr_b32 s7, s4, 2
    s_mul_i32 s7, s7, 7
    s_lshr_b32 s8, s5, 2
    s_add_u32 s7, s7, s8
    s_lshr_b32 s8, s3, 2
    s_lshl_b32 s9, s6, 1
    s_add_u32 s8, s8, s9
    s_lshr_b32 s9, s8, 4
    s_and_b32 s8, s8, 15
    s_lshl_b32 s8, s8, 6
    s_add_u32 s8, s8, s9
    s_and_b32 s9, s3, 1
    s_lshl_b32 s9, s9, 5
    s_add_u32 s8, s8, s9
    s_lshr_b32 s9, s3, 1
    s_and_b32 s9, s9, 1
    s_cmp_eq_u32 s9, 0
    s_cselect_b64 s[64:65], -1, 0
    v_lshlrev_b32 v6, 1, v2
    v_add_u32 v6, s8, v6
    v_mov_b32 v17, 1024
    v_add_u32 v7, 0, v6
    v_sub_u32 v16, 2048, v7
    v_cmp_eq_u32 vcc, 0, v7
    s_nop 1
    v_cndmask_b32 v16, v16, v17, vcc
    v_cndmask_b32 v7, v16, v7, s[64:65]
    v_lshlrev_b32 v7, 10, v7
    v_lshl_add_u32 v34, v3, 4, v7
    v_add_u32 v7, 8, v6
    v_sub_u32 v16, 2048, v7
    v_cmp_eq_u32 vcc, 0, v7
    s_nop 1
    v_cndmask_b32 v16, v16, v17, vcc
    v_cndmask_b32 v7, v16, v7, s[64:65]
    v_lshlrev_b32 v7, 10, v7
    v_lshl_add_u32 v35, v3, 4, v7
    v_add_u32 v7, 16, v6
    v_sub_u32 v16, 2048, v7
    v_cmp_eq_u32 vcc, 0, v7
    s_nop 1
    v_cndmask_b32 v16, v16, v17, vcc
    v_cndmask_b32 v7, v16, v7, s[64:65]
    v_lshlrev_b32 v7, 10, v7
    v_lshl_add_u32 v36, v3, 4, v7
    v_add_u32 v7, 24, v6
    v_sub_u32 v16, 2048, v7
    v_cmp_eq_u32 vcc, 0, v7
    s_nop 1
    v_cndmask_b32 v16, v16, v17, vcc
    v_cndmask_b32 v7, v16, v7, s[64:65]
    v_lshlrev_b32 v7, 10, v7
    v_lshl_add_u32 v37, v3, 4, v7
    s_waitcnt lgkmcnt(0)
    s_mov_b32 s36, s16
    s_and_b32 s37, s17, 0xffff
    s_mov_b32 s38, 0x200000
    s_mov_b32 s39, 0x20000
    buffer_load_dwordx4 v[192:195], v34, s[36:39], 0 offen offset:0
    buffer_load_dwordx4 v[196:199], v34, s[36:39], 0 offen offset:256
    buffer_load_dwordx4 v[200:203], v34, s[36:39], 0 offen offset:512
    buffer_load_dwordx4 v[204:207], v34, s[36:39], 0 offen offset:768
    buffer_load_dwordx4 v[208:211], v35, s[36:39], 0 offen offset:0
    buffer_load_dwordx4 v[212:215], v35, s[36:39], 0 offen offset:256
    buffer_load_dwordx4 v[216:219], v35, s[36:39], 0 offen offset:512
    buffer_load_dwordx4 v[220:223], v35, s[36:39], 0 offen offset:768
    buffer_load_dwordx4 v[224:227], v36, s[36:39], 0 offen offset:0
    buffer_load_dwordx4 v[228:231], v36, s[36:39], 0 offen offset:256
    buffer_load_dwordx4 v[232:235], v36, s[36:39], 0 offen offset:512
    buffer_load_dwordx4 v[236:239], v36, s[36:39], 0 offen offset:768
    buffer_load_dwordx4 v[240:243], v37, s[36:39], 0 offen offset:0
    buffer_load_dwordx4 v[244:247], v37, s[36:39], 0 offen offset:256
    buffer_load_dwordx4 v[248:251], v37, s[36:39], 0 offen offset:512
    buffer_load_dwordx4 v[252:255], v37, s[36:39], 0 offen offset:768
    s_mov_b32 s44, s28
    s_and_b32 s45, s29, 0xffff
    s_mov_b32 s46, 0x1c0000
    s_mov_b32 s47, 0x20000
    s_mov_b32 s48, s30
    s_and_b32 s49, s31, 0xffff
    s_mov_b32 s50, 0x1c0000
    s_mov_b32 s51, 0x20000
    s_mov_b32 s40, s66
    s_and_b32 s41, s67, 0xffff
    s_mov_b32 s42, 0xc00000
    s_mov_b32 s43, 0x20000
    s_mov_b32 s56, s32
    s_and_b32 s57, s33, 0xffff
    s_mov_b32 s58, 0x1c0000
    s_mov_b32 s59, 0x20000
    s_cmp_lt_u32 s2, 128
    s_cselect_b32 s52, s18, s20
    s_cselect_b32 s53, s19, s21
    s_and_b32 s53, s53, 0xffff
    s_mov_b32 s54, 0x800000
    s_mov_b32 s55, 0x20000
    s_lshr_b32 s8, s3, 1
    s_lshl_b32 s8, s8, 15
    s_and_b32 s9, s3, 1
    s_lshl_b32 s9, s9, 8
    s_add_u32 s8, s8, s9
    v_lshrrev_b32 v6, 1, v3
    v_lshlrev_b32 v6, 10, v6
    v_and_b32 v7, 1, v3
    v_lshlrev_b32 v7, 9, v7
    v_add3_u32 v6, v6, v7, s8
    v_and_b32 v7, 7, v3
    v_xor_b32 v16, v2, v7
    v_lshl_add_u32 v16, v16, 4, v6
    v_add_u32 v17, 4, v2
    v_xor_b32 v17, v17, v7
    v_lshl_add_u32 v17, v17, 4, v6
    s_cmp_lt_u32 s3, 4
    s_cbranch_scc1 G1_NP
    s_setprio 2
G1_NP:
    s_waitcnt vmcnt(12)
    v_dot2_f32_bf16 v24, v192, v38, 0
    v_dot2_f32_bf16 v25, v192, v192, 0
    v_dot2_f32_bf16 v32, v193, v38, 0
    v_dot2_f32_bf16 v33, v193, v193, 0
    v_dot2_f32_bf16 v24, v194, v38, v24
    v_dot2_f32_bf16 v25, v194, v194, v25
    v_dot2_f32_bf16 v32, v195, v38, v32
    v_dot2_f32_bf16 v33, v195, v195, v33
    v_dot2_f32_bf16 v24, v196, v38, v24
    v_dot2_f32_bf16 v25, v196, v196, v25
    v_dot2_f32_bf16 v32, v197, v38, v32
    v_dot2_f32_bf16 v33, v197, v197, v33
    v_dot2_f32_bf16 v24, v198, v38, v24
    v_dot2_f32_bf16 v25, v198, v198, v25
    v_dot2_f32_bf16 v32, v199, v38, v32
    v_dot2_f32_bf16 v33, v199, v199, v33
    v_dot2_f32_bf16 v24, v200, v38, v24
    v_dot2_f32_bf16 v25, v200, v200, v25
    v_dot2_f32_bf16 v32, v201, v38, v32
    v_dot2_f32_bf16 v33, v201, v201, v33
    v_dot2_f32_bf16 v24, v202, v38, v24
    v_dot2_f32_bf16 v25, v202, v202, v25
    v_dot2_f32_bf16 v32, v203, v38, v32
    v_dot2_f32_bf16 v33, v203, v203, v33
    v_dot2_f32_bf16 v24, v204, v38, v24
    v_dot2_f32_bf16 v25, v204, v204, v25
    v_dot2_f32_bf16 v32, v205, v38, v32
    v_dot2_f32_bf16 v33, v205, v205, v33
    v_dot2_f32_bf16 v24, v206, v38, v24
    v_dot2_f32_bf16 v25, v206, v206, v25
    v_dot2_f32_bf16 v32, v207, v38, v32
    v_dot2_f32_bf16 v33, v207, v207, v33
    v_lshlrev_b32 v64, 16, v192
    v_and_b32 v65, s60, v192
    v_lshlrev_b32 v66, 16, v193
    v_and_b32 v67, s60, v193
    v_lshlrev_b32 v68, 16, v194
    v_and_b32 v69, s60, v194
    v_lshlrev_b32 v70, 16, v195
    v_and_b32 v71, s60, v195
    v_lshlrev_b32 v72, 16, v196
    v_and_b32 v73, s60, v196
    v_lshlrev_b32 v74, 16, v197
    v_and_b32 v75, s60, v197
    v_lshlrev_b32 v76, 16, v198
    v_and_b32 v77, s60, v198
    v_lshlrev_b32 v78, 16, v199
    v_and_b32 v79, s60, v199
    v_lshlrev_b32 v80, 16, v200
    v_and_b32 v81, s60, v200
    v_lshlrev_b32 v82, 16, v201
    v_and_b32 v83, s60, v201
    v_lshlrev_b32 v84, 16, v202
    v_and_b32 v85, s60, v202
    v_lshlrev_b32 v86, 16, v203
    v_and_b32 v87, s60, v203
    v_lshlrev_b32 v88, 16, v204
    v_and_b32 v89, s60, v204
    v_lshlrev_b32 v90, 16, v205
    v_and_b32 v91, s60, v205
    v_lshlrev_b32 v92, 16, v206
    v_and_b32 v93, s60, v206
    v_lshlrev_b32 v94, 16, v207
    v_and_b32 v95, s60, v207
    v_add_f32 v24, v24, v32
    v_add_f32 v25, v25, v33
    s_waitcnt vmcnt(8)
    v_dot2_f32_bf16 v26, v208, v38, 0
    v_dot2_f32_bf16 v27, v208, v208, 0
    v_dot2_f32_bf16 v34, v209, v38, 0
    v_dot2_f32_bf16 v35, v209, v209, 0
    v_dot2_f32_bf16 v26, v210, v38, v26
    v_dot2_f32_bf16 v27, v210, v210, v27
    v_dot2_f32_bf16 v34, v211, v38, v34
    v_dot2_f32_bf16 v35, v211, v211, v35
    v_dot2_f32_bf16 v26, v212, v38, v26
    v_dot2_f32_bf16 v27, v212, v212, v27
    v_dot2_f32_bf16 v34, v213, v38, v34
    v_dot2_f32_bf16 v35, v213, v213, v35
    v_dot2_f32_bf16 v26, v214, v38, v26
    v_dot2_f32_bf16 v27, v214, v214, v27
    v_dot2_f32_bf16 v34, v215, v38, v34
    v_dot2_f32_bf16 v35, v215, v215, v35
    v_dot2_f32_bf16 v26, v216, v38, v26
    v_dot2_f32_bf16 v27, v216, v216, v27
    v_dot2_f32_bf16 v34, v217, v38, v34
    v_dot2_f32_bf16 v35, v217, v217, v35
    v_dot2_f32_bf16 v26, v218, v38, v26
    v_dot2_f32_bf16 v27, v218, v218, v27
    v_dot2_f32_bf16 v34, v219, v38, v34
    v_dot2_f32_bf16 v35, v219, v219, v35
    v_dot2_f32_bf16 v26, v220, v38, v26
    v_dot2_f32_bf16 v27, v220, v220, v27
    v_dot2_f32_bf16 v34, v221, v38, v34
    v_dot2_f32_bf16 v35, v221, v221, v35
    v_dot2_f32_bf16 v26, v222, v38, v26
    v_dot2_f32_bf16 v27, v222, v222, v27
    v_dot2_f32_bf16 v34, v223, v38, v34
    v_dot2_f32_bf16 v35, v223, v223, v35
    v_lshlrev_b32 v96, 16, v208
    v_and_b32 v97, s60, v208
    v_lshlrev_b32 v98, 16, v209
    v_and_b32 v99, s60, v209
    v_lshlrev_b32 v100, 16, v210
    v_and_b32 v101, s60, v210
    v_lshlrev_b32 v102, 16, v211
    v_and_b32 v103, s60, v211
    v_lshlrev_b32 v104, 16, v212
    v_and_b32 v105, s60, v212
    v_lshlrev_b32 v106, 16, v213
    v_and_b32 v107, s60, v213
    v_lshlrev_b32 v108, 16, v214
    v_and_b32 v109, s60, v214
    v_lshlrev_b32 v110, 16, v215
    v_and_b32 v111, s60, v215
    v_lshlrev_b32 v112, 16, v216
    v_and_b32 v113, s60, v216
    v_lshlrev_b32 v114, 16, v217
    v_and_b32 v115, s60, v217
    v_lshlrev_b32 v116, 16, v218
    v_and_b32 v117, s60, v218
    v_lshlrev_b32 v118, 16, v219
    v_and_b32 v119, s60, v219
    v_lshlrev_b32 v120, 16, v220
    v_and_b32 v121, s60, v220
    v_lshlrev_b32 v122, 16, v221
    v_and_b32 v123, s60, v221
    v_lshlrev_b32 v124, 16, v222
    v_and_b32 v125, s60, v222
    v_lshlrev_b32 v126, 16, v223
    v_and_b32 v127, s60, v223
    v_add_f32 v26, v26, v34
    v_add_f32 v27, v27, v35
    v_add_f32_dpp v24, v24, v24 row_ror:8 row_mask:0xf bank_mask:0xf
    v_add_f32_dpp v25, v25, v25 row_ror:8 row_mask:0xf bank_mask:0xf
    v_add_f32_dpp v26, v26, v26 row_ror:8 row_mask:0xf bank_mask:0xf
    v_add_f32_dpp v27, v27, v27 row_ror:8 row_mask:0xf bank_mask:0xf
    v_add_f32_dpp v24, v24, v24 row_ror:4 row_mask:0xf bank_mask:0xf
    v_add_f32_dpp v25, v25, v25 row_ror:4 row_mask:0xf bank_mask:0xf
    v_add_f32_dpp v26, v26, v26 row_ror:4 row_mask:0xf bank_mask:0xf
    v_add_f32_dpp v27, v27, v27 row_ror:4 row_mask:0xf bank_mask:0xf
    v_add_f32_dpp v24, v24, v24 row_ror:2 row_mask:0xf bank_mask:0xf
    v_add_f32_dpp v25, v25, v25 row_ror:2 row_mask:0xf bank_mask:0xf
    v_add_f32_dpp v26, v26, v26 row_ror:2 row_mask:0xf bank_mask:0xf
    v_add_f32_dpp v27, v27, v27 row_ror:2 row_mask:0xf bank_mask:0xf
    v_add_f32_dpp v24, v24, v24 row_ror:1 row_mask:0xf bank_mask:0xf
    v_add_f32_dpp v25, v25, v25 row_ror:1 row_mask:0xf bank_mask:0xf
    v_add_f32_dpp v26, v26, v26 row_ror:1 row_mask:0xf bank_mask:0xf
    v_add_f32_dpp v27, v27, v27 row_ror:1 row_mask:0xf bank_mask:0xf
    v_mul_f32 v49, 0xbb000000, v24
    v_mul_f32 v51, 0xbb000000, v26
    v_fma_f32 v25, v25, s61, v39
    v_fma_f32 v27, v27, s61, v39
    v_fma_f32 v25, -v49, v49, v25
    v_fma_f32 v27, -v51, v51, v27
    v_max_f32 v25, v25, v39
    v_max_f32 v27, v27, v39
    s_nop 0
    v_rsq_f32 v40, v25
    v_rsq_f32 v42, v27
    s_nop 0
    v_mul_f32 v48, v49, v40
    v_mul_f32 v50, v51, v42
    v_pk_fma_f32 v[64:65], v[64:65], v[40:41], v[48:49] op_sel_hi:[1,0,0]
    v_pk_fma_f32 v[66:67], v[66:67], v[40:41], v[48:49] op_sel_hi:[1,0,0]
    v_pk_fma_f32 v[68:69], v[68:69], v[40:41], v[48:49] op_sel_hi:[1,0,0]
    v_pk_fma_f32 v[70:71], v[70:71], v[40:41], v[48:49] op_sel_hi:[1,0,0]
    v_cvt_pk_bf16_f32 v192, v64, v65
    v_cvt_pk_bf16_f32 v193, v66, v67
    v_cvt_pk_bf16_f32 v194, v68, v69
    v_cvt_pk_bf16_f32 v195, v70, v71
    ds_write_b128 v16, v[192:195] offset:0
    v_pk_fma_f32 v[72:73], v[72:73], v[40:41], v[48:49] op_sel_hi:[1,0,0]
    v_pk_fma_f32 v[74:75], v[74:75], v[40:41], v[48:49] op_sel_hi:[1,0,0]
    v_pk_fma_f32 v[76:77], v[76:77], v[40:41], v[48:49] op_sel_hi:[1,0,0]
    v_pk_fma_f32 v[78:79], v[78:79], v[40:41], v[48:49] op_sel_hi:[1,0,0]
    v_cvt_pk_bf16_f32 v196, v72, v73
    v_cvt_pk_bf16_f32 v197, v74, v75
    v_cvt_pk_bf16_f32 v198, v76, v77
    v_cvt_pk_bf16_f32 v199, v78, v79
    ds_write_b128 v16, v[196:199] offset:8192
    v_pk_fma_f32 v[80:81], v[80:81], v[40:41], v[48:49] op_sel_hi:[1,0,0]
    v_pk_fma_f32 v[82:83], v[82:83], v[40:41], v[48:49] op_sel_hi:[1,0,0]
    v_pk_fma_f32 v[84:85], v[84:85], v[40:41], v[48:49] op_sel_hi:[1,0,0]
    v_pk_fma_f32 v[86:87], v[86:87], v[40:41], v[48:49] op_sel_hi:[1,0,0]
    v_cvt_pk_bf16_f32 v200, v80, v81
    v_cvt_pk_bf16_f32 v201, v82, v83
    v_cvt_pk_bf16_f32 v202, v84, v85
    v_cvt_pk_bf16_f32 v203, v86, v87
    ds_write_b128 v16, v[200:203] offset:16384
    v_pk_fma_f32 v[88:89], v[88:89], v[40:41], v[48:49] op_sel_hi:[1,0,0]
    v_pk_fma_f32 v[90:91], v[90:91], v[40:41], v[48:49] op_sel_hi:[1,0,0]
    v_pk_fma_f32 v[92:93], v[92:93], v[40:41], v[48:49] op_sel_hi:[1,0,0]
    v_pk_fma_f32 v[94:95], v[94:95], v[40:41], v[48:49] op_sel_hi:[1,0,0]
    v_cvt_pk_bf16_f32 v204, v88, v89
    v_cvt_pk_bf16_f32 v205, v90, v91
    v_cvt_pk_bf16_f32 v206, v92, v93
    v_cvt_pk_bf16_f32 v207, v94, v95
    ds_write_b128 v16, v[204:207] offset:24576
    v_pk_fma_f32 v[96:97], v[96:97], v[42:43], v[50:51] op_sel_hi:[1,0,0]
    v_pk_fma_f32 v[98:99], v[98:99], v[42:43], v[50:51] op_sel_hi:[1,0,0]
    v_pk_fma_f32 v[100:101], v[100:101], v[42:43], v[50:51] op_sel_hi:[1,0,0]
    v_pk_fma_f32 v[102:103], v[102:103], v[42:43], v[50:51] op_sel_hi:[1,0,0]
    v_cvt_pk_bf16_f32 v208, v96, v97
    v_cvt_pk_bf16_f32 v209, v98, v99
    v_cvt_pk_bf16_f32 v210, v100, v101
    v_cvt_pk_bf16_f32 v211, v102, v103
    ds_write_b128 v17, v[208:211] offset:0
    v_pk_fma_f32 v[104:105], v[104:105], v[42:43], v[50:51] op_sel_hi:[1,0,0]
    v_pk_fma_f32 v[106:107], v[106:107], v[42:43], v[50:51] op_sel_hi:[1,0,0]
    v_pk_fma_f32 v[108:109], v[108:109], v[42:43], v[50:51] op_sel_hi:[1,0,0]
    v_pk_fma_f32 v[110:111], v[110:111], v[42:43], v[50:51] op_sel_hi:[1,0,0]
    v_cvt_pk_bf16_f32 v212, v104, v105
    v_cvt_pk_bf16_f32 v213, v106, v107
    v_cvt_pk_bf16_f32 v214, v108, v109
    v_cvt_pk_bf16_f32 v215, v110, v111
    ds_write_b128 v17, v[212:215] offset:8192
    v_pk_fma_f32 v[112:113], v[112:113], v[42:43], v[50:51] op_sel_hi:[1,0,0]
    v_pk_fma_f32 v[114:115], v[114:115], v[42:43], v[50:51] op_sel_hi:[1,0,0]
    v_pk_fma_f32 v[116:117], v[116:117], v[42:43], v[50:51] op_sel_hi:[1,0,0]
    v_pk_fma_f32 v[118:119], v[118:119], v[42:43], v[50:51] op_sel_hi:[1,0,0]
    v_cvt_pk_bf16_f32 v216, v112, v113
    v_cvt_pk_bf16_f32 v217, v114, v115
    v_cvt_pk_bf16_f32 v218, v116, v117
    v_cvt_pk_bf16_f32 v219, v118, v119
    ds_write_b128 v17, v[216:219] offset:16384
    v_pk_fma_f32 v[120:121], v[120:121], v[42:43], v[50:51] op_sel_hi:[1,0,0]
    v_pk_fma_f32 v[122:123], v[122:123], v[42:43], v[50:51] op_sel_hi:[1,0,0]
    v_pk_fma_f32 v[124:125], v[124:125], v[42:43], v[50:51] op_sel_hi:[1,0,0]
    v_pk_fma_f32 v[126:127], v[126:127], v[42:43], v[50:51] op_sel_hi:[1,0,0]
    v_cvt_pk_bf16_f32 v220, v120, v121
    v_cvt_pk_bf16_f32 v221, v122, v123
    v_cvt_pk_bf16_f32 v222, v124, v125
    v_cvt_pk_bf16_f32 v223, v126, v127
    ds_write_b128 v17, v[220:223] offset:24576
    s_and_b32 s8, s3, 1
    s_cmp_eq_u32 s8, 0
    s_cselect_b32 s92, s44, s48
    s_cselect_b32 s93, s45, s49
    s_mov_b32 s94, 0x1C0000
    s_mov_b32 s95, 0x20000
    v_mul_u32_u24 v6, 3584, v2
    v_lshlrev_b32 v7, 2, v2
    v_xor_b32 v7, v7, v3
    v_lshlrev_b32 v7, 4, v7
    s_lshl_b32 s9, s7, 8
    v_add3_u32 v20, v6, v7, s9
    s_lshr_b32 s9, s3, 1
    s_mul_i32 s63, s9, 57344
    s_lshl_b32 s62, s9, 13
    s_lshl_b32 s8, s8, 12
    s_add_u32 s62, s62, s8
    s_add_u32 s62, s62, 131072
    s_add_u32 m0, s62, 0
    s_add_u32 s8, s63, 0
    buffer_load_dwordx4 v20, s[92:95], s8 offen lds
    s_add_u32 m0, s62, 1024
    s_add_u32 s8, s63, 14336
    buffer_load_dwordx4 v20, s[92:95], s8 offen lds
    s_add_u32 m0, s62, 2048
    s_add_u32 s8, s63, 28672
    buffer_load_dwordx4 v20, s[92:95], s8 offen lds
    s_add_u32 m0, s62, 3072
    s_add_u32 s8, s63, 43008
    buffer_load_dwordx4 v20, s[92:95], s8 offen lds
    s_and_b32 s8, s6, 3
    s_lshl_b32 s8, s8, 2
    s_lshr_b32 s9, s3, 1
    s_add_u32 s8, s8, s9
    s_lshl_b32 s8, s8, 5
    v_lshrrev_b32 v6, 1, v1
    v_add_u32 v6, s8, v6
    v_mul_u32_u24 v6, 3584, v6
    v_and_b32 v7, 1, v1
    v_lshlrev_b32 v7, 7, v7
    s_lshl_b32 s9, s7, 8
    v_add3_u32 v6, v6, v7, s9
    buffer_load_dword v47, v6, s[92:95], 0 offen
    s_mul_i32 s8, s70, 14336
    v_add_u32 v20, s8, v20
    s_lshl_b32 s62, s70, 10
    s_add_u32 s62, s62, 131072
    s_mov_b32 s63, 229376
    s_waitcnt vmcnt(9)
    v_dot2_f32_bf16 v28, v224, v38, 0
    v_dot2_f32_bf16 v29, v224, v224, 0
    v_dot2_f32_bf16 v32, v225, v38, 0
    v_dot2_f32_bf16 v33, v225, v225, 0
    v_dot2_f32_bf16 v28, v226, v38, v28
    v_dot2_f32_bf16 v29, v226, v226, v29
    v_dot2_f32_bf16 v32, v227, v38, v32
    v_dot2_f32_bf16 v33, v227, v227, v33
    v_dot2_f32_bf16 v28, v228, v38, v28
    v_dot2_f32_bf16 v29, v228, v228, v29
    v_dot2_f32_bf16 v32, v229, v38, v32
    v_dot2_f32_bf16 v33, v229, v229, v33
    v_dot2_f32_bf16 v28, v230, v38, v28
    v_dot2_f32_bf16 v29, v230, v230, v29
    v_dot2_f32_bf16 v32, v231, v38, v32
    v_dot2_f32_bf16 v33, v231, v231, v33
    v_dot2_f32_bf16 v28, v232, v38, v28
    v_dot2_f32_bf16 v29, v232, v232, v29
    v_dot2_f32_bf16 v32, v233, v38, v32
    v_dot2_f32_bf16 v33, v233, v233, v33
    v_dot2_f32_bf16 v28, v234, v38, v28
    v_dot2_f32_bf16 v29, v234, v234, v29
    v_dot2_f32_bf16 v32, v235, v38, v32
    v_dot2_f32_bf16 v33, v235, v235, v33
    v_dot2_f32_bf16 v28, v236, v38, v28
    v_dot2_f32_bf16 v29, v236, v236, v29
    v_dot2_f32_bf16 v32, v237, v38, v32
    v_dot2_f32_bf16 v33, v237, v237, v33
    v_dot2_f32_bf16 v28, v238, v38, v28
    v_dot2_f32_bf16 v29, v238, v238, v29
    v_dot2_f32_bf16 v32, v239, v38, v32
    v_dot2_f32_bf16 v33, v239, v239, v33
    v_lshlrev_b32 v128, 16, v224
    v_and_b32 v129, s60, v224
    v_lshlrev_b32 v130, 16, v225
    v_and_b32 v131, s60, v225
    v_lshlrev_b32 v132, 16, v226
    v_and_b32 v133, s60, v226
    v_lshlrev_b32 v134, 16, v227
    v_and_b32 v135, s60, v227
    v_lshlrev_b32 v136, 16, v228
    v_and_b32 v137, s60, v228
    v_lshlrev_b32 v138, 16, v229
    v_and_b32 v139, s60, v229
    v_lshlrev_b32 v140, 16, v230
    v_and_b32 v141, s60, v230
    v_lshlrev_b32 v142, 16, v231
    v_and_b32 v143, s60, v231
    v_lshlrev_b32 v144, 16, v232
    v_and_b32 v145, s60, v232
    v_lshlrev_b32 v146, 16, v233
    v_and_b32 v147, s60, v233
    v_lshlrev_b32 v148, 16, v234
    v_and_b32 v149, s60, v234
    v_lshlrev_b32 v150, 16, v235
    v_and_b32 v151, s60, v235
    v_lshlrev_b32 v152, 16, v236
    v_and_b32 v153, s60, v236
    v_lshlrev_b32 v154, 16, v237
    v_and_b32 v155, s60, v237
    v_lshlrev_b32 v156, 16, v238
    v_and_b32 v157, s60, v238
    v_lshlrev_b32 v158, 16, v239
    v_and_b32 v159, s60, v239
    v_add_f32 v28, v28, v32
    v_add_f32 v29, v29, v33
    s_waitcnt vmcnt(5)
    v_dot2_f32_bf16 v30, v240, v38, 0
    v_dot2_f32_bf16 v31, v240, v240, 0
    v_dot2_f32_bf16 v34, v241, v38, 0
    v_dot2_f32_bf16 v35, v241, v241, 0
    v_dot2_f32_bf16 v30, v242, v38, v30
    v_dot2_f32_bf16 v31, v242, v242, v31
    v_dot2_f32_bf16 v34, v243, v38, v34
    v_dot2_f32_bf16 v35, v243, v243, v35
    v_dot2_f32_bf16 v30, v244, v38, v30
    v_dot2_f32_bf16 v31, v244, v244, v31
    v_dot2_f32_bf16 v34, v245, v38, v34
    v_dot2_f32_bf16 v35, v245, v245, v35
    v_dot2_f32_bf16 v30, v246, v38, v30
    v_dot2_f32_bf16 v31, v246, v246, v31
    v_dot2_f32_bf16 v34, v247, v38, v34
    v_dot2_f32_bf16 v35, v247, v247, v35
    v_dot2_f32_bf16 v30, v248, v38, v30
    v_dot2_f32_bf16 v31, v248, v248, v31
    v_dot2_f32_bf16 v34, v249, v38, v34
    v_dot2_f32_bf16 v35, v249, v249, v35
    v_dot2_f32_bf16 v30, v250, v38, v30
    v_dot2_f32_bf16 v31, v250, v250, v31
    v_dot2_f32_bf16 v34, v251, v38, v34
    v_dot2_f32_bf16 v35, v251, v251, v35
    v_dot2_f32_bf16 v30, v252, v38, v30
    v_dot2_f32_bf16 v31, v252, v252, v31
    v_dot2_f32_bf16 v34, v253, v38, v34
    v_dot2_f32_bf16 v35, v253, v253, v35
    v_dot2_f32_bf16 v30, v254, v38, v30
    v_dot2_f32_bf16 v31, v254, v254, v31
    v_dot2_f32_bf16 v34, v255, v38, v34
    v_dot2_f32_bf16 v35, v255, v255, v35
    v_lshlrev_b32 v160, 16, v240
    v_and_b32 v161, s60, v240
    v_lshlrev_b32 v162, 16, v241
    v_and_b32 v163, s60, v241
    v_lshlrev_b32 v164, 16, v242
    v_and_b32 v165, s60, v242
    v_lshlrev_b32 v166, 16, v243
    v_and_b32 v167, s60, v243
    v_lshlrev_b32 v168, 16, v244
    v_and_b32 v169, s60, v244
    v_lshlrev_b32 v170, 16, v245
    v_and_b32 v171, s60, v245
    v_lshlrev_b32 v172, 16, v246
    v_and_b32 v173, s60, v246
    v_lshlrev_b32 v174, 16, v247
    v_and_b32 v175, s60, v247
    v_lshlrev_b32 v176, 16, v248
    v_and_b32 v177, s60, v248
    v_lshlrev_b32 v178, 16, v249
    v_and_b32 v179, s60, v249
    v_lshlrev_b32 v180, 16, v250
    v_and_b32 v181, s60, v250
    v_lshlrev_b32 v182, 16, v251
    v_and_b32 v183, s60, v251
    v_lshlrev_b32 v184, 16, v252
    v_and_b32 v185, s60, v252
    v_lshlrev_b32 v186, 16, v253
    v_and_b32 v187, s60, v253
    v_lshlrev_b32 v188, 16, v254
    v_and_b32 v189, s60, v254
    v_lshlrev_b32 v190, 16, v255
    v_and_b32 v191, s60, v255
    v_add_f32 v30, v30, v34
    v_add_f32 v31, v31, v35
    v_add_f32_dpp v28, v28, v28 row_ror:8 row_mask:0xf bank_mask:0xf
    v_add_f32_dpp v29, v29, v29 row_ror:8 row_mask:0xf bank_mask:0xf
    v_add_f32_dpp v30, v30, v30 row_ror:8 row_mask:0xf bank_mask:0xf
    v_add_f32_dpp v31, v31, v31 row_ror:8 row_mask:0xf bank_mask:0xf
    v_add_f32_dpp v28, v28, v28 row_ror:4 row_mask:0xf bank_mask:0xf
    v_add_f32_dpp v29, v29, v29 row_ror:4 row_mask:0xf bank_mask:0xf
    v_add_f32_dpp v30, v30, v30 row_ror:4 row_mask:0xf bank_mask:0xf
    v_add_f32_dpp v31, v31, v31 row_ror:4 row_mask:0xf bank_mask:0xf
    v_add_f32_dpp v28, v28, v28 row_ror:2 row_mask:0xf bank_mask:0xf
    v_add_f32_dpp v29, v29, v29 row_ror:2 row_mask:0xf bank_mask:0xf
    v_add_f32_dpp v30, v30, v30 row_ror:2 row_mask:0xf bank_mask:0xf
    v_add_f32_dpp v31, v31, v31 row_ror:2 row_mask:0xf bank_mask:0xf
    v_add_f32_dpp v28, v28, v28 row_ror:1 row_mask:0xf bank_mask:0xf
    v_add_f32_dpp v29, v29, v29 row_ror:1 row_mask:0xf bank_mask:0xf
    v_add_f32_dpp v30, v30, v30 row_ror:1 row_mask:0xf bank_mask:0xf
    v_add_f32_dpp v31, v31, v31 row_ror:1 row_mask:0xf bank_mask:0xf
    v_mul_f32 v53, 0xbb000000, v28
    v_mul_f32 v55, 0xbb000000, v30
    v_fma_f32 v29, v29, s61, v39
    v_fma_f32 v31, v31, s61, v39
    v_fma_f32 v29, -v53, v53, v29
    v_fma_f32 v31, -v55, v55, v31
    v_max_f32 v29, v29, v39
    v_max_f32 v31, v31, v39
    s_nop 0
    v_rsq_f32 v44, v29
    v_rsq_f32 v46, v31
    s_nop 0
    v_mul_f32 v52, v53, v44
    v_mul_f32 v54, v55, v46
    v_pk_fma_f32 v[128:129], v[128:129], v[44:45], v[52:53] op_sel_hi:[1,0,0]
    v_pk_fma_f32 v[130:131], v[130:131], v[44:45], v[52:53] op_sel_hi:[1,0,0]
    v_pk_fma_f32 v[132:133], v[132:133], v[44:45], v[52:53] op_sel_hi:[1,0,0]
    v_pk_fma_f32 v[134:135], v[134:135], v[44:45], v[52:53] op_sel_hi:[1,0,0]
    v_cvt_pk_bf16_f32 v224, v128, v129
    v_cvt_pk_bf16_f32 v225, v130, v131
    v_cvt_pk_bf16_f32 v226, v132, v133
    v_cvt_pk_bf16_f32 v227, v134, v135
    ds_write_b128 v16, v[224:227] offset:128
    v_pk_fma_f32 v[136:137], v[136:137], v[44:45], v[52:53] op_sel_hi:[1,0,0]
    v_pk_fma_f32 v[138:139], v[138:139], v[44:45], v[52:53] op_sel_hi:[1,0,0]
    v_pk_fma_f32 v[140:141], v[140:141], v[44:45], v[52:53] op_sel_hi:[1,0,0]
    v_pk_fma_f32 v[142:143], v[142:143], v[44:45], v[52:53] op_sel_hi:[1,0,0]
    v_cvt_pk_bf16_f32 v228, v136, v137
    v_cvt_pk_bf16_f32 v229, v138, v139
    v_cvt_pk_bf16_f32 v230, v140, v141
    v_cvt_pk_bf16_f32 v231, v142, v143
    ds_write_b128 v16, v[228:231] offset:8320
    v_pk_fma_f32 v[144:145], v[144:145], v[44:45], v[52:53] op_sel_hi:[1,0,0]
    v_pk_fma_f32 v[146:147], v[146:147], v[44:45], v[52:53] op_sel_hi:[1,0,0]
    v_pk_fma_f32 v[148:149], v[148:149], v[44:45], v[52:53] op_sel_hi:[1,0,0]
    v_pk_fma_f32 v[150:151], v[150:151], v[44:45], v[52:53] op_sel_hi:[1,0,0]
    v_cvt_pk_bf16_f32 v232, v144, v145
    v_cvt_pk_bf16_f32 v233, v146, v147
    v_cvt_pk_bf16_f32 v234, v148, v149
    v_cvt_pk_bf16_f32 v235, v150, v151
    ds_write_b128 v16, v[232:235] offset:16512
    v_pk_fma_f32 v[152:153], v[152:153], v[44:45], v[52:53] op_sel_hi:[1,0,0]
    v_pk_fma_f32 v[154:155], v[154:155], v[44:45], v[52:53] op_sel_hi:[1,0,0]
    v_pk_fma_f32 v[156:157], v[156:157], v[44:45], v[52:53] op_sel_hi:[1,0,0]
    v_pk_fma_f32 v[158:159], v[158:159], v[44:45], v[52:53] op_sel_hi:[1,0,0]
    v_cvt_pk_bf16_f32 v236, v152, v153
    v_cvt_pk_bf16_f32 v237, v154, v155
    v_cvt_pk_bf16_f32 v238, v156, v157
    v_cvt_pk_bf16_f32 v239, v158, v159
    ds_write_b128 v16, v[236:239] offset:24704
    v_pk_fma_f32 v[160:161], v[160:161], v[46:47], v[54:55] op_sel_hi:[1,0,0]
    v_pk_fma_f32 v[162:163], v[162:163], v[46:47], v[54:55] op_sel_hi:[1,0,0]
    v_pk_fma_f32 v[164:165], v[164:165], v[46:47], v[54:55] op_sel_hi:[1,0,0]
    v_pk_fma_f32 v[166:167], v[166:167], v[46:47], v[54:55] op_sel_hi:[1,0,0]
    v_cvt_pk_bf16_f32 v240, v160, v161
    v_cvt_pk_bf16_f32 v241, v162, v163
    v_cvt_pk_bf16_f32 v242, v164, v165
    v_cvt_pk_bf16_f32 v243, v166, v167
    ds_write_b128 v17, v[240:243] offset:128
    v_pk_fma_f32 v[168:169], v[168:169], v[46:47], v[54:55] op_sel_hi:[1,0,0]
    v_pk_fma_f32 v[170:171], v[170:171], v[46:47], v[54:55] op_sel_hi:[1,0,0]
    v_pk_fma_f32 v[172:173], v[172:173], v[46:47], v[54:55] op_sel_hi:[1,0,0]
    v_pk_fma_f32 v[174:175], v[174:175], v[46:47], v[54:55] op_sel_hi:[1,0,0]
    v_cvt_pk_bf16_f32 v244, v168, v169
    v_cvt_pk_bf16_f32 v245, v170, v171
    v_cvt_pk_bf16_f32 v246, v172, v173
    v_cvt_pk_bf16_f32 v247, v174, v175
    ds_write_b128 v17, v[244:247] offset:8320
    v_pk_fma_f32 v[176:177], v[176:177], v[46:47], v[54:55] op_sel_hi:[1,0,0]
    v_pk_fma_f32 v[178:179], v[178:179], v[46:47], v[54:55] op_sel_hi:[1,0,0]
    v_pk_fma_f32 v[180:181], v[180:181], v[46:47], v[54:55] op_sel_hi:[1,0,0]
    v_pk_fma_f32 v[182:183], v[182:183], v[46:47], v[54:55] op_sel_hi:[1,0,0]
    v_cvt_pk_bf16_f32 v248, v176, v177
    v_cvt_pk_bf16_f32 v249, v178, v179
    v_cvt_pk_bf16_f32 v250, v180, v181
    v_cvt_pk_bf16_f32 v251, v182, v183
    ds_write_b128 v17, v[248:251] offset:16512
    v_pk_fma_f32 v[184:185], v[184:185], v[46:47], v[54:55] op_sel_hi:[1,0,0]
    v_pk_fma_f32 v[186:187], v[186:187], v[46:47], v[54:55] op_sel_hi:[1,0,0]
    v_pk_fma_f32 v[188:189], v[188:189], v[46:47], v[54:55] op_sel_hi:[1,0,0]
    v_pk_fma_f32 v[190:191], v[190:191], v[46:47], v[54:55] op_sel_hi:[1,0,0]
    v_cvt_pk_bf16_f32 v252, v184, v185
    v_cvt_pk_bf16_f32 v253, v186, v187
    v_cvt_pk_bf16_f32 v254, v188, v189
    v_cvt_pk_bf16_f32 v255, v190, v191
    ds_write_b128 v17, v[252:255] offset:24704
    s_waitcnt vmcnt(1)
    s_setprio 0
    s_cmp_lt_u32 s3, 4
    s_cbranch_scc1 G1_CONS
    s_waitcnt lgkmcnt(0)
    s_barrier
    s_barrier
    s_add_u32 m0, s62, 0
    s_nop 0
    buffer_load_dwordx4 v20, s[44:47], s63 offen lds
    s_add_u32 m0, s62, 4096
    s_nop 0
    buffer_load_dwordx4 v20, s[48:51], s63 offen lds
    s_add_u32 s63, s63, 57344
    s_barrier
    s_add_u32 m0, s62, 8192
    s_nop 0
    buffer_load_dwordx4 v20, s[44:47], s63 offen lds
    s_add_u32 m0, s62, 12288
    s_nop 0
    buffer_load_dwordx4 v20, s[48:51], s63 offen lds
    s_add_u32 s63, s63, 57344
    s_barrier
    s_add_u32 m0, s62, 16384
    s_nop 0
    buffer_load_dwordx4 v20, s[44:47], s63 offen lds
    s_add_u32 m0, s62, 20480
    s_nop 0
    buffer_load_dwordx4 v20, s[48:51], s63 offen lds
    s_add_u32 s63, s63, 57344
    s_waitcnt vmcnt(4)
    s_barrier
    s_add_u32 m0, s62, 24576
    s_nop 0
    buffer_load_dwordx4 v20, s[44:47], s63 offen lds
    s_add_u32 m0, s62, 28672
    s_nop 0
    buffer_load_dwordx4 v20, s[48:51], s63 offen lds
    s_add_u32 s63, s63, 57344
    s_waitcnt vmcnt(4)
    s_barrier
    s_add_u32 m0, s62, 0
    s_nop 0
    buffer_load_dwordx4 v20, s[44:47], s63 offen lds
    s_add_u32 m0, s62, 4096
    s_nop 0
    buffer_load_dwordx4 v20, s[48:51], s63 offen lds
    s_add_u32 s63, s63, 57344
    s_waitcnt vmcnt(4)
    s_barrier
    s_add_u32 m0, s62, 8192
    s_nop 0
    buffer_load_dwordx4 v20, s[44:47], s63 offen lds
    s_add_u32 m0, s62, 12288
    s_nop 0
    buffer_load_dwordx4 v20, s[48:51], s63 offen lds
    s_add_u32 s63, s63, 57344
    s_waitcnt vmcnt(4)
    s_barrier
    s_add_u32 m0, s62, 16384
    s_nop 0
    buffer_load_dwordx4 v20, s[44:47], s63 offen lds
    s_add_u32 m0, s62, 20480
    s_nop 0
    buffer_load_dwordx4 v20, s[48:51], s63 offen lds
    s_add_u32 s63, s63, 57344
    s_waitcnt vmcnt(4)
    s_barrier
    s_add_u32 m0, s62, 24576
    s_nop 0
    buffer_load_dwordx4 v20, s[44:47], s63 offen lds
    s_add_u32 m0, s62, 28672
    s_nop 0
    buffer_load_dwordx4 v20, s[48:51], s63 offen lds
    s_add_u32 s63, s63, 57344
    s_waitcnt vmcnt(4)
    s_barrier
    s_add_u32 m0, s62, 0
    s_nop 0
    buffer_load_dwordx4 v20, s[44:47], s63 offen lds
    s_add_u32 m0, s62, 4096
    s_nop 0
    buffer_load_dwordx4 v20, s[48:51], s63 offen lds
    s_add_u32 s63, s63, 57344
    s_waitcnt vmcnt(4)
    s_barrier
    s_add_u32 m0, s62, 8192
    s_nop 0
    buffer_load_dwordx4 v20, s[44:47], s63 offen lds
    s_add_u32 m0, s62, 12288
    s_nop 0
    buffer_load_dwordx4 v20, s[48:51], s63 offen lds
    s_add_u32 s63, s63, 57344
    v_lshlrev_b32 v10, 4, v1
    s_lshr_b32 s8, s6, 1
    s_lshl_b32 s8, s8, 5
    v_add_u32 v11, s8, v4
    v_mov_b32 v12, 256
    v_cmp_eq_u32 vcc, 0, v11
    s_nop 1
    v_cndmask_b32 v12, v11, v12, vcc
    v_sub_u32 v11, 512, v11
    v_and_b32 v11, 511, v11
    s_and_b32 s8, s6, 1
    s_cmp_eq_u32 s8, 0
    s_cselect_b64 s[64:65], -1, 0
    s_nop 0
    v_cndmask_b32 v11, v11, v12, s[64:65]
    v_lshlrev_b32 v11, 1, v11
    s_lshl_b32 s8, s7, 3
    s_add_u32 s8, s8, s70
    s_lshl_b32 s9, s8, 14
    v_lshlrev_b32 v12, 12, v5
    v_add3_u32 v11, v11, v12, s9
    s_mul_i32 s9, s6, 112
    s_add_u32 s9, s9, s8
    s_lshl_b32 s9, s9, 10
    s_add_u32 s9, s9, 7340032
    v_add_u32 v62, s9, v10
    s_mov_b32 s64, 8192
    s_mov_b32 s65, 65536
    s_mov_b32 s66, 73728
    s_waitcnt vmcnt(4)
    s_barrier
    s_add_u32 m0, s62, 16384
    s_nop 0
    buffer_load_dwordx4 v20, s[44:47], s63 offen lds
    s_add_u32 m0, s62, 20480
    s_nop 0
    buffer_load_dwordx4 v20, s[48:51], s63 offen lds
    s_add_u32 s63, s63, 57344
    s_waitcnt vmcnt(4)
    s_barrier
    s_add_u32 m0, s62, 24576
    s_nop 0
    buffer_load_dwordx4 v20, s[44:47], s63 offen lds
    s_add_u32 m0, s62, 28672
    s_nop 0
    buffer_load_dwordx4 v20, s[48:51], s63 offen lds
    s_add_u32 s63, s63, 57344
    buffer_load_ushort v80, v11, s[56:59], 0 offen offset:0
    buffer_load_ushort v81, v11, s[56:59], 0 offen offset:1024
    s_waitcnt vmcnt(6)
    s_barrier
    s_add_u32 m0, s62, 0
    s_nop 0
    buffer_load_dwordx4 v20, s[44:47], s63 offen lds
    s_add_u32 m0, s62, 4096
    s_nop 0
    buffer_load_dwordx4 v20, s[48:51], s63 offen lds
    s_add_u32 s63, s63, 57344
    buffer_load_ushort v82, v11, s[56:59], 0 offen offset:2048
    buffer_load_ushort v83, v11, s[56:59], 0 offen offset:3072
    s_waitcnt vmcnt(8)
    s_barrier
    s_add_u32 m0, s62, 8192
    s_nop 0
    buffer_load_dwordx4 v20, s[44:47], s63 offen lds
    s_add_u32 m0, s62, 12288
    s_nop 0
    buffer_load_dwordx4 v20, s[48:51], s63 offen lds
    s_add_u32 s63, s63, 57344
    buffer_load_ushort v84, v11, s[56:59], s64 offen offset:0
    buffer_load_ushort v85, v11, s[56:59], s64 offen offset:1024
    s_waitcnt vmcnt(10)
    s_barrier
    s_add_u32 m0, s62, 16384
    s_nop 0
    buffer_load_dwordx4 v20, s[44:47], s63 offen lds
    s_add_u32 m0, s62, 20480
    s_nop 0
    buffer_load_dwordx4 v20, s[48:51], s63 offen lds
    s_add_u32 s63, s63, 57344
    buffer_load_ushort v86, v11, s[56:59], s64 offen offset:2048
    buffer_load_ushort v87, v11, s[56:59], s64 offen offset:3072
    s_waitcnt vmcnt(10)
    s_barrier
    s_add_u32 m0, s62, 24576
    s_nop 0
    buffer_load_dwordx4 v20, s[44:47], s63 offen lds
    s_add_u32 m0, s62, 28672
    s_nop 0
    buffer_load_dwordx4 v20, s[48:51], s63 offen lds
    s_add_u32 s63, s63, 57344
    buffer_load_ushort v88, v11, s[56:59], s65 offen offset:0
    buffer_load_ushort v89, v11, s[56:59], s65 offen offset:1024
    s_waitcnt vmcnt(10)
    s_barrier
    s_add_u32 m0, s62, 0
    s_nop 0
    buffer_load_dwordx4 v20, s[44:47], s63 offen lds
    s_add_u32 m0, s62, 4096
    s_nop 0
    buffer_load_dwordx4 v20, s[48:51], s63 offen lds
    s_add_u32 s63, s63, 57344
    buffer_load_ushort v90, v11, s[56:59], s65 offen offset:2048
    buffer_load_ushort v91, v11, s[56:59], s65 offen offset:3072
    s_waitcnt vmcnt(10)
    s_barrier
    s_add_u32 m0, s62, 8192
    s_nop 0
    buffer_load_dwordx4 v20, s[44:47], s63 offen lds
    s_add_u32 m0, s62, 12288
    s_nop 0
    buffer_load_dwordx4 v20, s[48:51], s63 offen lds
    s_add_u32 s63, s63, 57344
    buffer_load_ushort v92, v11, s[56:59], s66 offen offset:0
    buffer_load_ushort v93, v11, s[56:59], s66 offen offset:1024
    s_waitcnt vmcnt(10)
    s_barrier
    s_add_u32 m0, s62, 16384
    s_nop 0
    buffer_load_dwordx4 v20, s[44:47], s63 offen lds
    s_add_u32 m0, s62, 20480
    s_nop 0
    buffer_load_dwordx4 v20, s[48:51], s63 offen lds
    s_add_u32 s63, s63, 57344
    buffer_load_ushort v94, v11, s[56:59], s66 offen offset:2048
    buffer_load_ushort v95, v11, s[56:59], s66 offen offset:3072
    s_waitcnt vmcnt(10)
    s_barrier
    s_add_u32 m0, s62, 24576
    s_nop 0
    buffer_load_dwordx4 v20, s[44:47], s63 offen lds
    s_add_u32 m0, s62, 28672
    s_nop 0
    buffer_load_dwordx4 v20, s[48:51], s63 offen lds
    s_add_u32 s63, s63, 57344
    s_waitcnt vmcnt(8)
    s_barrier
    s_add_u32 m0, s62, 0
    s_nop 0
    buffer_load_dwordx4 v20, s[44:47], s63 offen lds
    s_add_u32 m0, s62, 4096
    s_nop 0
    buffer_load_dwordx4 v20, s[48:51], s63 offen lds
    s_add_u32 s63, s63, 57344
    s_waitcnt vmcnt(6)
    s_barrier
    s_add_u32 m0, s62, 8192
    s_nop 0
    buffer_load_dwordx4 v20, s[44:47], s63 offen lds
    s_add_u32 m0, s62, 12288
    s_nop 0
    buffer_load_dwordx4 v20, s[48:51], s63 offen lds
    s_add_u32 s63, s63, 57344
    s_waitcnt vmcnt(4)
    s_barrier
    s_add_u32 m0, s62, 16384
    s_nop 0
    buffer_load_dwordx4 v20, s[44:47], s63 offen lds
    s_add_u32 m0, s62, 20480
    s_nop 0
    buffer_load_dwordx4 v20, s[48:51], s63 offen lds
    s_add_u32 s63, s63, 57344
    s_waitcnt vmcnt(8)
    v_lshl_or_b32 v96, v81, 16, v80
    v_lshl_or_b32 v97, v83, 16, v82
    v_lshl_or_b32 v98, v85, 16, v84
    v_lshl_or_b32 v99, v87, 16, v86
    v_lshl_or_b32 v100, v89, 16, v88
    v_lshl_or_b32 v101, v91, 16, v90
    v_lshl_or_b32 v102, v93, 16, v92
    v_lshl_or_b32 v103, v95, 16, v94
    buffer_store_dwordx4 v[96:99], v62, s[40:43], 0 offen
    v_add_u32 v63, 4096, v62
    buffer_store_dwordx4 v[100:103], v63, s[40:43], 0 offen
    s_waitcnt vmcnt(6)
    s_barrier
    s_add_u32 m0, s62, 24576
    s_nop 0
    buffer_load_dwordx4 v20, s[44:47], s63 offen lds
    s_add_u32 m0, s62, 28672
    s_nop 0
    buffer_load_dwordx4 v20, s[48:51], s63 offen lds
    s_add_u32 s63, s63, 57344
    s_waitcnt vmcnt(6)
    s_barrier
    s_add_u32 m0, s62, 0
    s_nop 0
    buffer_load_dwordx4 v20, s[44:47], s63 offen lds
    s_add_u32 m0, s62, 4096
    s_nop 0
    buffer_load_dwordx4 v20, s[48:51], s63 offen lds
    s_add_u32 s63, s63, 57344
    s_waitcnt vmcnt(6)
    s_barrier
    s_add_u32 m0, s62, 8192
    s_nop 0
    buffer_load_dwordx4 v20, s[44:47], s63 offen lds
    s_add_u32 m0, s62, 12288
    s_nop 0
    buffer_load_dwordx4 v20, s[48:51], s63 offen lds
    s_add_u32 s63, s63, 57344
    s_waitcnt vmcnt(4)
    s_barrier
    s_add_u32 m0, s62, 16384
    s_nop 0
    buffer_load_dwordx4 v20, s[44:47], s63 offen lds
    s_add_u32 m0, s62, 20480
    s_nop 0
    buffer_load_dwordx4 v20, s[48:51], s63 offen lds
    s_add_u32 s63, s63, 57344
    s_waitcnt vmcnt(4)
    s_barrier
    s_add_u32 m0, s62, 24576
    s_nop 0
    buffer_load_dwordx4 v20, s[44:47], s63 offen lds
    s_add_u32 m0, s62, 28672
    s_nop 0
    buffer_load_dwordx4 v20, s[48:51], s63 offen lds
    s_add_u32 s63, s63, 57344
    s_waitcnt vmcnt(4)
    s_barrier
    s_waitcnt vmcnt(2)
    s_barrier
    s_waitcnt vmcnt(0)
    s_barrier
    s_branch K1_FIN
G1_CONS:
    s_lshr_b32 s8, s6, 1
    s_lshl_b32 s8, s8, 6
    s_sub_u32 s9, 960, s8
    s_and_b32 s10, s6, 1
    s_cmp_eq_u32 s10, 0
    s_cselect_b32 s8, s8, s9
    s_lshr_b32 s9, s3, 1
    s_lshl_b32 s9, s9, 6
    s_add_u32 s8, s8, s9
    s_lshl_b32 s9, s7, 7
    s_and_b32 s10, s3, 1
    s_lshl_b32 s10, s10, 6
    s_add_u32 s9, s9, s10
    v_add_u32 v113, s9, v1
    v_lshlrev_b32 v113, 10, v113
    v_add_u32 v113, s8, v113
    buffer_load_dword v112, v113, s[56:59], 0 offen
    s_lshr_b32 s8, s3, 1
    s_and_b32 s9, s3, 1
    v_lshrrev_b32 v8, 2, v3
    v_and_b32 v9, 3, v3
    v_and_b32 v10, 1, v2
    v_lshlrev_b32 v10, 1, v10
    v_lshrrev_b32 v11, 1, v9
    v_add_u32 v10, v10, v11
    v_and_b32 v11, 1, v9
    v_lshlrev_b32 v11, 3, v11
    v_lshlrev_b32 v12, 3, v5
    v_add_u32 v12, v12, v8
    v_lshlrev_b32 v12, 8, v12
    v_add_u32 v12, 131072, v12
    v_add_u32 v12, v12, v11
    s_lshl_b32 s10, s8, 1
    v_xor_b32 v13, s10, v8
    v_lshl_add_u32 v13, v13, 2, v10
    v_lshl_add_u32 v6, v13, 4, v12
    s_add_u32 s10, s10, 1
    v_xor_b32 v13, s10, v8
    v_lshl_add_u32 v13, v13, 2, v10
    v_lshl_add_u32 v7, v13, 4, v12
    s_lshl_b32 s10, s9, 16
    v_lshlrev_b32 v12, 9, v5
    v_add_u32 v12, s10, v12
    v_add_u32 v13, 0, v5
    v_xor_b32 v13, v13, v4
    v_lshl_add_u32 v16, v13, 4, v12
    v_add_u32 v13, 2, v5
    v_xor_b32 v13, v13, v4
    v_lshl_add_u32 v17, v13, 4, v12
    v_add_u32 v13, 4, v5
    v_xor_b32 v13, v13, v4
    v_lshl_add_u32 v18, v13, 4, v12
    v_add_u32 v13, 6, v5
    v_xor_b32 v13, v13, v4
    v_lshl_add_u32 v19, v13, 4, v12
    s_waitcnt lgkmcnt(0)
    s_barrier
    s_setprio 1
    ds_read_b128 v[80:83], v16 offset:0
    ds_read_b128 v[84:87], v16 offset:32768
    ds_read_b64_tr_b16 v[64:65], v6 offset:0
    ds_read_b64_tr_b16 v[66:67], v6 offset:1024
    ds_read_b64_tr_b16 v[68:69], v6 offset:4096
    ds_read_b64_tr_b16 v[70:71], v6 offset:5120
    ds_read_b64_tr_b16 v[72:73], v7 offset:0
    ds_read_b64_tr_b16 v[74:75], v7 offset:1024
    ds_read_b64_tr_b16 v[76:77], v7 offset:4096
    ds_read_b64_tr_b16 v[78:79], v7 offset:5120
    s_waitcnt lgkmcnt(0)
    s_barrier
    v_mfma_f32_32x32x16_bf16 v[128:143], v[64:67], v[80:83], 0
    ds_read_b128 v[104:107], v17 offset:1024
    ds_read_b128 v[108:111], v17 offset:33792
    v_mfma_f32_32x32x16_bf16 v[160:175], v[64:67], v[84:87], 0
    ds_read_b64_tr_b16 v[88:89], v6 offset:8192
    ds_read_b64_tr_b16 v[90:91], v6 offset:9216
    v_mfma_f32_32x32x16_bf16 v[144:159], v[68:71], v[80:83], 0
    ds_read_b64_tr_b16 v[92:93], v6 offset:12288
    ds_read_b64_tr_b16 v[94:95], v6 offset:13312
    v_mfma_f32_32x32x16_bf16 v[176:191], v[68:71], v[84:87], 0
    ds_read_b64_tr_b16 v[96:97], v7 offset:8192
    ds_read_b64_tr_b16 v[98:99], v7 offset:9216
    v_mfma_f32_32x32x16_bf16 v[192:207], v[72:75], v[80:83], 0
    ds_read_b64_tr_b16 v[100:101], v7 offset:12288
    ds_read_b64_tr_b16 v[102:103], v7 offset:13312
    v_mfma_f32_32x32x16_bf16 v[224:239], v[72:75], v[84:87], 0
    v_mfma_f32_32x32x16_bf16 v[208:223], v[76:79], v[80:83], 0
    v_mfma_f32_32x32x16_bf16 v[240:255], v[76:79], v[84:87], 0
    s_waitcnt lgkmcnt(0)
    s_barrier
    v_mfma_f32_32x32x16_bf16 v[128:143], v[88:91], v[104:107], v[128:143]
    ds_read_b128 v[80:83], v18 offset:2048
    ds_read_b128 v[84:87], v18 offset:34816
    v_mfma_f32_32x32x16_bf16 v[160:175], v[88:91], v[108:111], v[160:175]
    ds_read_b64_tr_b16 v[64:65], v6 offset:16384
    ds_read_b64_tr_b16 v[66:67], v6 offset:17408
    v_mfma_f32_32x32x16_bf16 v[144:159], v[92:95], v[104:107], v[144:159]
    ds_read_b64_tr_b16 v[68:69], v6 offset:20480
    ds_read_b64_tr_b16 v[70:71], v6 offset:21504
    v_mfma_f32_32x32x16_bf16 v[176:191], v[92:95], v[108:111], v[176:191]
    ds_read_b64_tr_b16 v[72:73], v7 offset:16384
    ds_read_b64_tr_b16 v[74:75], v7 offset:17408
    v_mfma_f32_32x32x16_bf16 v[192:207], v[96:99], v[104:107], v[192:207]
    ds_read_b64_tr_b16 v[76:77], v7 offset:20480
    ds_read_b64_tr_b16 v[78:79], v7 offset:21504
    v_mfma_f32_32x32x16_bf16 v[224:239], v[96:99], v[108:111], v[224:239]
    v_mfma_f32_32x32x16_bf16 v[208:223], v[100:103], v[104:107], v[208:223]
    v_mfma_f32_32x32x16_bf16 v[240:255], v[100:103], v[108:111], v[240:255]
    s_waitcnt lgkmcnt(0)
    s_barrier
    v_mfma_f32_32x32x16_bf16 v[128:143], v[64:67], v[80:83], v[128:143]
    ds_read_b128 v[104:107], v19 offset:3072
    ds_read_b128 v[108:111], v19 offset:35840
    v_mfma_f32_32x32x16_bf16 v[160:175], v[64:67], v[84:87], v[160:175]
    ds_read_b64_tr_b16 v[88:89], v6 offset:24576
    ds_read_b64_tr_b16 v[90:91], v6 offset:25600
    v_mfma_f32_32x32x16_bf16 v[144:159], v[68:71], v[80:83], v[144:159]
    ds_read_b64_tr_b16 v[92:93], v6 offset:28672
    ds_read_b64_tr_b16 v[94:95], v6 offset:29696
    v_mfma_f32_32x32x16_bf16 v[176:191], v[68:71], v[84:87], v[176:191]
    ds_read_b64_tr_b16 v[96:97], v7 offset:24576
    ds_read_b64_tr_b16 v[98:99], v7 offset:25600
    v_mfma_f32_32x32x16_bf16 v[192:207], v[72:75], v[80:83], v[192:207]
    ds_read_b64_tr_b16 v[100:101], v7 offset:28672
    ds_read_b64_tr_b16 v[102:103], v7 offset:29696
    v_mfma_f32_32x32x16_bf16 v[224:239], v[72:75], v[84:87], v[224:239]
    v_mfma_f32_32x32x16_bf16 v[208:223], v[76:79], v[80:83], v[208:223]
    v_mfma_f32_32x32x16_bf16 v[240:255], v[76:79], v[84:87], v[240:255]
    s_waitcnt lgkmcnt(0)
    s_barrier
    v_mfma_f32_32x32x16_bf16 v[128:143], v[88:91], v[104:107], v[128:143]
    ds_read_b128 v[80:83], v16 offset:4096
    ds_read_b128 v[84:87], v16 offset:36864
    v_mfma_f32_32x32x16_bf16 v[160:175], v[88:91], v[108:111], v[160:175]
    ds_read_b64_tr_b16 v[64:65], v6 offset:0
    ds_read_b64_tr_b16 v[66:67], v6 offset:1024
    v_mfma_f32_32x32x16_bf16 v[144:159], v[92:95], v[104:107], v[144:159]
    ds_read_b64_tr_b16 v[68:69], v6 offset:4096
    ds_read_b64_tr_b16 v[70:71], v6 offset:5120
    v_mfma_f32_32x32x16_bf16 v[176:191], v[92:95], v[108:111], v[176:191]
    ds_read_b64_tr_b16 v[72:73], v7 offset:0
    ds_read_b64_tr_b16 v[74:75], v7 offset:1024
    v_mfma_f32_32x32x16_bf16 v[192:207], v[96:99], v[104:107], v[192:207]
    ds_read_b64_tr_b16 v[76:77], v7 offset:4096
    ds_read_b64_tr_b16 v[78:79], v7 offset:5120
    v_mfma_f32_32x32x16_bf16 v[224:239], v[96:99], v[108:111], v[224:239]
    v_mfma_f32_32x32x16_bf16 v[208:223], v[100:103], v[104:107], v[208:223]
    v_mfma_f32_32x32x16_bf16 v[240:255], v[100:103], v[108:111], v[240:255]
    s_waitcnt lgkmcnt(0)
    s_barrier
    v_mfma_f32_32x32x16_bf16 v[128:143], v[64:67], v[80:83], v[128:143]
    ds_read_b128 v[104:107], v17 offset:5120
    ds_read_b128 v[108:111], v17 offset:37888
    v_mfma_f32_32x32x16_bf16 v[160:175], v[64:67], v[84:87], v[160:175]
    ds_read_b64_tr_b16 v[88:89], v6 offset:8192
    ds_read_b64_tr_b16 v[90:91], v6 offset:9216
    v_mfma_f32_32x32x16_bf16 v[144:159], v[68:71], v[80:83], v[144:159]
    ds_read_b64_tr_b16 v[92:93], v6 offset:12288
    ds_read_b64_tr_b16 v[94:95], v6 offset:13312
    v_mfma_f32_32x32x16_bf16 v[176:191], v[68:71], v[84:87], v[176:191]
    ds_read_b64_tr_b16 v[96:97], v7 offset:8192
    ds_read_b64_tr_b16 v[98:99], v7 offset:9216
    v_mfma_f32_32x32x16_bf16 v[192:207], v[72:75], v[80:83], v[192:207]
    ds_read_b64_tr_b16 v[100:101], v7 offset:12288
    ds_read_b64_tr_b16 v[102:103], v7 offset:13312
    v_mfma_f32_32x32x16_bf16 v[224:239], v[72:75], v[84:87], v[224:239]
    v_mfma_f32_32x32x16_bf16 v[208:223], v[76:79], v[80:83], v[208:223]
    v_mfma_f32_32x32x16_bf16 v[240:255], v[76:79], v[84:87], v[240:255]
    s_waitcnt lgkmcnt(0)
    s_barrier
    v_mfma_f32_32x32x16_bf16 v[128:143], v[88:91], v[104:107], v[128:143]
    ds_read_b128 v[80:83], v18 offset:6144
    ds_read_b128 v[84:87], v18 offset:38912
    v_mfma_f32_32x32x16_bf16 v[160:175], v[88:91], v[108:111], v[160:175]
    ds_read_b64_tr_b16 v[64:65], v6 offset:16384
    ds_read_b64_tr_b16 v[66:67], v6 offset:17408
    v_mfma_f32_32x32x16_bf16 v[144:159], v[92:95], v[104:107], v[144:159]
    ds_read_b64_tr_b16 v[68:69], v6 offset:20480
    ds_read_b64_tr_b16 v[70:71], v6 offset:21504
    v_mfma_f32_32x32x16_bf16 v[176:191], v[92:95], v[108:111], v[176:191]
    ds_read_b64_tr_b16 v[72:73], v7 offset:16384
    ds_read_b64_tr_b16 v[74:75], v7 offset:17408
    v_mfma_f32_32x32x16_bf16 v[192:207], v[96:99], v[104:107], v[192:207]
    ds_read_b64_tr_b16 v[76:77], v7 offset:20480
    ds_read_b64_tr_b16 v[78:79], v7 offset:21504
    v_mfma_f32_32x32x16_bf16 v[224:239], v[96:99], v[108:111], v[224:239]
    v_mfma_f32_32x32x16_bf16 v[208:223], v[100:103], v[104:107], v[208:223]
    v_mfma_f32_32x32x16_bf16 v[240:255], v[100:103], v[108:111], v[240:255]
    s_waitcnt lgkmcnt(0)
    s_barrier
    v_mfma_f32_32x32x16_bf16 v[128:143], v[64:67], v[80:83], v[128:143]
    ds_read_b128 v[104:107], v19 offset:7168
    ds_read_b128 v[108:111], v19 offset:39936
    v_mfma_f32_32x32x16_bf16 v[160:175], v[64:67], v[84:87], v[160:175]
    ds_read_b64_tr_b16 v[88:89], v6 offset:24576
    ds_read_b64_tr_b16 v[90:91], v6 offset:25600
    v_mfma_f32_32x32x16_bf16 v[144:159], v[68:71], v[80:83], v[144:159]
    ds_read_b64_tr_b16 v[92:93], v6 offset:28672
    ds_read_b64_tr_b16 v[94:95], v6 offset:29696
    v_mfma_f32_32x32x16_bf16 v[176:191], v[68:71], v[84:87], v[176:191]
    ds_read_b64_tr_b16 v[96:97], v7 offset:24576
    ds_read_b64_tr_b16 v[98:99], v7 offset:25600
    v_mfma_f32_32x32x16_bf16 v[192:207], v[72:75], v[80:83], v[192:207]
    ds_read_b64_tr_b16 v[100:101], v7 offset:28672
    ds_read_b64_tr_b16 v[102:103], v7 offset:29696
    v_mfma_f32_32x32x16_bf16 v[224:239], v[72:75], v[84:87], v[224:239]
    v_mfma_f32_32x32x16_bf16 v[208:223], v[76:79], v[80:83], v[208:223]
    v_mfma_f32_32x32x16_bf16 v[240:255], v[76:79], v[84:87], v[240:255]
    s_waitcnt lgkmcnt(0)
    s_barrier
    v_mfma_f32_32x32x16_bf16 v[128:143], v[88:91], v[104:107], v[128:143]
    ds_read_b128 v[80:83], v16 offset:8192
    ds_read_b128 v[84:87], v16 offset:40960
    v_mfma_f32_32x32x16_bf16 v[160:175], v[88:91], v[108:111], v[160:175]
    ds_read_b64_tr_b16 v[64:65], v6 offset:0
    ds_read_b64_tr_b16 v[66:67], v6 offset:1024
    v_mfma_f32_32x32x16_bf16 v[144:159], v[92:95], v[104:107], v[144:159]
    ds_read_b64_tr_b16 v[68:69], v6 offset:4096
    ds_read_b64_tr_b16 v[70:71], v6 offset:5120
    v_mfma_f32_32x32x16_bf16 v[176:191], v[92:95], v[108:111], v[176:191]
    ds_read_b64_tr_b16 v[72:73], v7 offset:0
    ds_read_b64_tr_b16 v[74:75], v7 offset:1024
    v_mfma_f32_32x32x16_bf16 v[192:207], v[96:99], v[104:107], v[192:207]
    ds_read_b64_tr_b16 v[76:77], v7 offset:4096
    ds_read_b64_tr_b16 v[78:79], v7 offset:5120
    v_mfma_f32_32x32x16_bf16 v[224:239], v[96:99], v[108:111], v[224:239]
    v_mfma_f32_32x32x16_bf16 v[208:223], v[100:103], v[104:107], v[208:223]
    v_mfma_f32_32x32x16_bf16 v[240:255], v[100:103], v[108:111], v[240:255]
    s_waitcnt lgkmcnt(0)
    s_barrier
    v_mfma_f32_32x32x16_bf16 v[128:143], v[64:67], v[80:83], v[128:143]
    ds_read_b128 v[104:107], v17 offset:9216
    ds_read_b128 v[108:111], v17 offset:41984
    v_mfma_f32_32x32x16_bf16 v[160:175], v[64:67], v[84:87], v[160:175]
    ds_read_b64_tr_b16 v[88:89], v6 offset:8192
    ds_read_b64_tr_b16 v[90:91], v6 offset:9216
    v_mfma_f32_32x32x16_bf16 v[144:159], v[68:71], v[80:83], v[144:159]
    ds_read_b64_tr_b16 v[92:93], v6 offset:12288
    ds_read_b64_tr_b16 v[94:95], v6 offset:13312
    v_mfma_f32_32x32x16_bf16 v[176:191], v[68:71], v[84:87], v[176:191]
    ds_read_b64_tr_b16 v[96:97], v7 offset:8192
    ds_read_b64_tr_b16 v[98:99], v7 offset:9216
    v_mfma_f32_32x32x16_bf16 v[192:207], v[72:75], v[80:83], v[192:207]
    ds_read_b64_tr_b16 v[100:101], v7 offset:12288
    ds_read_b64_tr_b16 v[102:103], v7 offset:13312
    v_mfma_f32_32x32x16_bf16 v[224:239], v[72:75], v[84:87], v[224:239]
    v_mfma_f32_32x32x16_bf16 v[208:223], v[76:79], v[80:83], v[208:223]
    v_mfma_f32_32x32x16_bf16 v[240:255], v[76:79], v[84:87], v[240:255]
    s_waitcnt lgkmcnt(0)
    s_barrier
    v_mfma_f32_32x32x16_bf16 v[128:143], v[88:91], v[104:107], v[128:143]
    ds_read_b128 v[80:83], v18 offset:10240
    ds_read_b128 v[84:87], v18 offset:43008
    v_mfma_f32_32x32x16_bf16 v[160:175], v[88:91], v[108:111], v[160:175]
    ds_read_b64_tr_b16 v[64:65], v6 offset:16384
    ds_read_b64_tr_b16 v[66:67], v6 offset:17408
    v_mfma_f32_32x32x16_bf16 v[144:159], v[92:95], v[104:107], v[144:159]
    ds_read_b64_tr_b16 v[68:69], v6 offset:20480
    ds_read_b64_tr_b16 v[70:71], v6 offset:21504
    v_mfma_f32_32x32x16_bf16 v[176:191], v[92:95], v[108:111], v[176:191]
    ds_read_b64_tr_b16 v[72:73], v7 offset:16384
    ds_read_b64_tr_b16 v[74:75], v7 offset:17408
    v_mfma_f32_32x32x16_bf16 v[192:207], v[96:99], v[104:107], v[192:207]
    ds_read_b64_tr_b16 v[76:77], v7 offset:20480
    ds_read_b64_tr_b16 v[78:79], v7 offset:21504
    v_mfma_f32_32x32x16_bf16 v[224:239], v[96:99], v[108:111], v[224:239]
    v_mfma_f32_32x32x16_bf16 v[208:223], v[100:103], v[104:107], v[208:223]
    v_mfma_f32_32x32x16_bf16 v[240:255], v[100:103], v[108:111], v[240:255]
    s_waitcnt lgkmcnt(0)
    s_barrier
    v_mfma_f32_32x32x16_bf16 v[128:143], v[64:67], v[80:83], v[128:143]
    ds_read_b128 v[104:107], v19 offset:11264
    ds_read_b128 v[108:111], v19 offset:44032
    v_mfma_f32_32x32x16_bf16 v[160:175], v[64:67], v[84:87], v[160:175]
    ds_read_b64_tr_b16 v[88:89], v6 offset:24576
    ds_read_b64_tr_b16 v[90:91], v6 offset:25600
    v_mfma_f32_32x32x16_bf16 v[144:159], v[68:71], v[80:83], v[144:159]
    ds_read_b64_tr_b16 v[92:93], v6 offset:28672
    ds_read_b64_tr_b16 v[94:95], v6 offset:29696
    v_mfma_f32_32x32x16_bf16 v[176:191], v[68:71], v[84:87], v[176:191]
    ds_read_b64_tr_b16 v[96:97], v7 offset:24576
    ds_read_b64_tr_b16 v[98:99], v7 offset:25600
    v_mfma_f32_32x32x16_bf16 v[192:207], v[72:75], v[80:83], v[192:207]
    ds_read_b64_tr_b16 v[100:101], v7 offset:28672
    ds_read_b64_tr_b16 v[102:103], v7 offset:29696
    v_mfma_f32_32x32x16_bf16 v[224:239], v[72:75], v[84:87], v[224:239]
    v_mfma_f32_32x32x16_bf16 v[208:223], v[76:79], v[80:83], v[208:223]
    v_mfma_f32_32x32x16_bf16 v[240:255], v[76:79], v[84:87], v[240:255]
    s_waitcnt lgkmcnt(0)
    s_barrier
    v_mfma_f32_32x32x16_bf16 v[128:143], v[88:91], v[104:107], v[128:143]
    ds_read_b128 v[80:83], v16 offset:12288
    ds_read_b128 v[84:87], v16 offset:45056
    v_mfma_f32_32x32x16_bf16 v[160:175], v[88:91], v[108:111], v[160:175]
    ds_read_b64_tr_b16 v[64:65], v6 offset:0
    ds_read_b64_tr_b16 v[66:67], v6 offset:1024
    v_mfma_f32_32x32x16_bf16 v[144:159], v[92:95], v[104:107], v[144:159]
    ds_read_b64_tr_b16 v[68:69], v6 offset:4096
    ds_read_b64_tr_b16 v[70:71], v6 offset:5120
    v_mfma_f32_32x32x16_bf16 v[176:191], v[92:95], v[108:111], v[176:191]
    ds_read_b64_tr_b16 v[72:73], v7 offset:0
    ds_read_b64_tr_b16 v[74:75], v7 offset:1024
    v_mfma_f32_32x32x16_bf16 v[192:207], v[96:99], v[104:107], v[192:207]
    ds_read_b64_tr_b16 v[76:77], v7 offset:4096
    ds_read_b64_tr_b16 v[78:79], v7 offset:5120
    v_mfma_f32_32x32x16_bf16 v[224:239], v[96:99], v[108:111], v[224:239]
    v_mfma_f32_32x32x16_bf16 v[208:223], v[100:103], v[104:107], v[208:223]
    v_mfma_f32_32x32x16_bf16 v[240:255], v[100:103], v[108:111], v[240:255]
    s_waitcnt lgkmcnt(0)
    s_barrier
    v_mfma_f32_32x32x16_bf16 v[128:143], v[64:67], v[80:83], v[128:143]
    ds_read_b128 v[104:107], v17 offset:13312
    ds_read_b128 v[108:111], v17 offset:46080
    v_mfma_f32_32x32x16_bf16 v[160:175], v[64:67], v[84:87], v[160:175]
    ds_read_b64_tr_b16 v[88:89], v6 offset:8192
    ds_read_b64_tr_b16 v[90:91], v6 offset:9216
    v_mfma_f32_32x32x16_bf16 v[144:159], v[68:71], v[80:83], v[144:159]
    ds_read_b64_tr_b16 v[92:93], v6 offset:12288
    ds_read_b64_tr_b16 v[94:95], v6 offset:13312
    v_mfma_f32_32x32x16_bf16 v[176:191], v[68:71], v[84:87], v[176:191]
    ds_read_b64_tr_b16 v[96:97], v7 offset:8192
    ds_read_b64_tr_b16 v[98:99], v7 offset:9216
    v_mfma_f32_32x32x16_bf16 v[192:207], v[72:75], v[80:83], v[192:207]
    ds_read_b64_tr_b16 v[100:101], v7 offset:12288
    ds_read_b64_tr_b16 v[102:103], v7 offset:13312
    v_mfma_f32_32x32x16_bf16 v[224:239], v[72:75], v[84:87], v[224:239]
    v_mfma_f32_32x32x16_bf16 v[208:223], v[76:79], v[80:83], v[208:223]
    v_mfma_f32_32x32x16_bf16 v[240:255], v[76:79], v[84:87], v[240:255]
    s_waitcnt lgkmcnt(0)
    s_barrier
    v_mfma_f32_32x32x16_bf16 v[128:143], v[88:91], v[104:107], v[128:143]
    ds_read_b128 v[80:83], v18 offset:14336
    ds_read_b128 v[84:87], v18 offset:47104
    v_mfma_f32_32x32x16_bf16 v[160:175], v[88:91], v[108:111], v[160:175]
    ds_read_b64_tr_b16 v[64:65], v6 offset:16384
    ds_read_b64_tr_b16 v[66:67], v6 offset:17408
    v_mfma_f32_32x32x16_bf16 v[144:159], v[92:95], v[104:107], v[144:159]
    ds_read_b64_tr_b16 v[68:69], v6 offset:20480
    ds_read_b64_tr_b16 v[70:71], v6 offset:21504
    v_mfma_f32_32x32x16_bf16 v[176:191], v[92:95], v[108:111], v[176:191]
    ds_read_b64_tr_b16 v[72:73], v7 offset:16384
    ds_read_b64_tr_b16 v[74:75], v7 offset:17408
    v_mfma_f32_32x32x16_bf16 v[192:207], v[96:99], v[104:107], v[192:207]
    ds_read_b64_tr_b16 v[76:77], v7 offset:20480
    ds_read_b64_tr_b16 v[78:79], v7 offset:21504
    v_mfma_f32_32x32x16_bf16 v[224:239], v[96:99], v[108:111], v[224:239]
    v_mfma_f32_32x32x16_bf16 v[208:223], v[100:103], v[104:107], v[208:223]
    v_mfma_f32_32x32x16_bf16 v[240:255], v[100:103], v[108:111], v[240:255]
    s_waitcnt lgkmcnt(0)
    s_barrier
    v_mfma_f32_32x32x16_bf16 v[128:143], v[64:67], v[80:83], v[128:143]
    ds_read_b128 v[104:107], v19 offset:15360
    ds_read_b128 v[108:111], v19 offset:48128
    v_mfma_f32_32x32x16_bf16 v[160:175], v[64:67], v[84:87], v[160:175]
    ds_read_b64_tr_b16 v[88:89], v6 offset:24576
    ds_read_b64_tr_b16 v[90:91], v6 offset:25600
    v_mfma_f32_32x32x16_bf16 v[144:159], v[68:71], v[80:83], v[144:159]
    ds_read_b64_tr_b16 v[92:93], v6 offset:28672
    ds_read_b64_tr_b16 v[94:95], v6 offset:29696
    v_mfma_f32_32x32x16_bf16 v[176:191], v[68:71], v[84:87], v[176:191]
    ds_read_b64_tr_b16 v[96:97], v7 offset:24576
    ds_read_b64_tr_b16 v[98:99], v7 offset:25600
    v_mfma_f32_32x32x16_bf16 v[192:207], v[72:75], v[80:83], v[192:207]
    ds_read_b64_tr_b16 v[100:101], v7 offset:28672
    ds_read_b64_tr_b16 v[102:103], v7 offset:29696
    v_mfma_f32_32x32x16_bf16 v[224:239], v[72:75], v[84:87], v[224:239]
    v_mfma_f32_32x32x16_bf16 v[208:223], v[76:79], v[80:83], v[208:223]
    v_mfma_f32_32x32x16_bf16 v[240:255], v[76:79], v[84:87], v[240:255]
    s_waitcnt lgkmcnt(0)
    s_barrier
    v_mfma_f32_32x32x16_bf16 v[128:143], v[88:91], v[104:107], v[128:143]
    ds_read_b128 v[80:83], v16 offset:16384
    ds_read_b128 v[84:87], v16 offset:49152
    v_mfma_f32_32x32x16_bf16 v[160:175], v[88:91], v[108:111], v[160:175]
    ds_read_b64_tr_b16 v[64:65], v6 offset:0
    ds_read_b64_tr_b16 v[66:67], v6 offset:1024
    v_mfma_f32_32x32x16_bf16 v[144:159], v[92:95], v[104:107], v[144:159]
    ds_read_b64_tr_b16 v[68:69], v6 offset:4096
    ds_read_b64_tr_b16 v[70:71], v6 offset:5120
    v_mfma_f32_32x32x16_bf16 v[176:191], v[92:95], v[108:111], v[176:191]
    ds_read_b64_tr_b16 v[72:73], v7 offset:0
    ds_read_b64_tr_b16 v[74:75], v7 offset:1024
    v_mfma_f32_32x32x16_bf16 v[192:207], v[96:99], v[104:107], v[192:207]
    ds_read_b64_tr_b16 v[76:77], v7 offset:4096
    ds_read_b64_tr_b16 v[78:79], v7 offset:5120
    v_mfma_f32_32x32x16_bf16 v[224:239], v[96:99], v[108:111], v[224:239]
    v_mfma_f32_32x32x16_bf16 v[208:223], v[100:103], v[104:107], v[208:223]
    v_mfma_f32_32x32x16_bf16 v[240:255], v[100:103], v[108:111], v[240:255]
    s_waitcnt lgkmcnt(0)
    s_barrier
    v_mfma_f32_32x32x16_bf16 v[128:143], v[64:67], v[80:83], v[128:143]
    ds_read_b128 v[104:107], v17 offset:17408
    ds_read_b128 v[108:111], v17 offset:50176
    v_mfma_f32_32x32x16_bf16 v[160:175], v[64:67], v[84:87], v[160:175]
    ds_read_b64_tr_b16 v[88:89], v6 offset:8192
    ds_read_b64_tr_b16 v[90:91], v6 offset:9216
    v_mfma_f32_32x32x16_bf16 v[144:159], v[68:71], v[80:83], v[144:159]
    ds_read_b64_tr_b16 v[92:93], v6 offset:12288
    ds_read_b64_tr_b16 v[94:95], v6 offset:13312
    v_mfma_f32_32x32x16_bf16 v[176:191], v[68:71], v[84:87], v[176:191]
    ds_read_b64_tr_b16 v[96:97], v7 offset:8192
    ds_read_b64_tr_b16 v[98:99], v7 offset:9216
    v_mfma_f32_32x32x16_bf16 v[192:207], v[72:75], v[80:83], v[192:207]
    ds_read_b64_tr_b16 v[100:101], v7 offset:12288
    ds_read_b64_tr_b16 v[102:103], v7 offset:13312
    v_mfma_f32_32x32x16_bf16 v[224:239], v[72:75], v[84:87], v[224:239]
    v_mfma_f32_32x32x16_bf16 v[208:223], v[76:79], v[80:83], v[208:223]
    v_mfma_f32_32x32x16_bf16 v[240:255], v[76:79], v[84:87], v[240:255]
    s_waitcnt lgkmcnt(0)
    s_barrier
    v_mfma_f32_32x32x16_bf16 v[128:143], v[88:91], v[104:107], v[128:143]
    ds_read_b128 v[80:83], v18 offset:18432
    ds_read_b128 v[84:87], v18 offset:51200
    v_mfma_f32_32x32x16_bf16 v[160:175], v[88:91], v[108:111], v[160:175]
    ds_read_b64_tr_b16 v[64:65], v6 offset:16384
    ds_read_b64_tr_b16 v[66:67], v6 offset:17408
    v_mfma_f32_32x32x16_bf16 v[144:159], v[92:95], v[104:107], v[144:159]
    ds_read_b64_tr_b16 v[68:69], v6 offset:20480
    ds_read_b64_tr_b16 v[70:71], v6 offset:21504
    v_mfma_f32_32x32x16_bf16 v[176:191], v[92:95], v[108:111], v[176:191]
    ds_read_b64_tr_b16 v[72:73], v7 offset:16384
    ds_read_b64_tr_b16 v[74:75], v7 offset:17408
    v_mfma_f32_32x32x16_bf16 v[192:207], v[96:99], v[104:107], v[192:207]
    ds_read_b64_tr_b16 v[76:77], v7 offset:20480
    ds_read_b64_tr_b16 v[78:79], v7 offset:21504
    v_mfma_f32_32x32x16_bf16 v[224:239], v[96:99], v[108:111], v[224:239]
    v_mfma_f32_32x32x16_bf16 v[208:223], v[100:103], v[104:107], v[208:223]
    v_mfma_f32_32x32x16_bf16 v[240:255], v[100:103], v[108:111], v[240:255]
    s_waitcnt lgkmcnt(0)
    s_barrier
    v_mfma_f32_32x32x16_bf16 v[128:143], v[64:67], v[80:83], v[128:143]
    ds_read_b128 v[104:107], v19 offset:19456
    ds_read_b128 v[108:111], v19 offset:52224
    v_mfma_f32_32x32x16_bf16 v[160:175], v[64:67], v[84:87], v[160:175]
    ds_read_b64_tr_b16 v[88:89], v6 offset:24576
    ds_read_b64_tr_b16 v[90:91], v6 offset:25600
    v_mfma_f32_32x32x16_bf16 v[144:159], v[68:71], v[80:83], v[144:159]
    ds_read_b64_tr_b16 v[92:93], v6 offset:28672
    ds_read_b64_tr_b16 v[94:95], v6 offset:29696
    v_mfma_f32_32x32x16_bf16 v[176:191], v[68:71], v[84:87], v[176:191]
    ds_read_b64_tr_b16 v[96:97], v7 offset:24576
    ds_read_b64_tr_b16 v[98:99], v7 offset:25600
    v_mfma_f32_32x32x16_bf16 v[192:207], v[72:75], v[80:83], v[192:207]
    ds_read_b64_tr_b16 v[100:101], v7 offset:28672
    ds_read_b64_tr_b16 v[102:103], v7 offset:29696
    v_mfma_f32_32x32x16_bf16 v[224:239], v[72:75], v[84:87], v[224:239]
    v_mfma_f32_32x32x16_bf16 v[208:223], v[76:79], v[80:83], v[208:223]
    v_mfma_f32_32x32x16_bf16 v[240:255], v[76:79], v[84:87], v[240:255]
    s_waitcnt lgkmcnt(0)
    s_barrier
    v_mfma_f32_32x32x16_bf16 v[128:143], v[88:91], v[104:107], v[128:143]
    ds_read_b128 v[80:83], v16 offset:20480
    ds_read_b128 v[84:87], v16 offset:53248
    v_mfma_f32_32x32x16_bf16 v[160:175], v[88:91], v[108:111], v[160:175]
    ds_read_b64_tr_b16 v[64:65], v6 offset:0
    ds_read_b64_tr_b16 v[66:67], v6 offset:1024
    v_mfma_f32_32x32x16_bf16 v[144:159], v[92:95], v[104:107], v[144:159]
    ds_read_b64_tr_b16 v[68:69], v6 offset:4096
    ds_read_b64_tr_b16 v[70:71], v6 offset:5120
    v_mfma_f32_32x32x16_bf16 v[176:191], v[92:95], v[108:111], v[176:191]
    ds_read_b64_tr_b16 v[72:73], v7 offset:0
    ds_read_b64_tr_b16 v[74:75], v7 offset:1024
    v_mfma_f32_32x32x16_bf16 v[192:207], v[96:99], v[104:107], v[192:207]
    ds_read_b64_tr_b16 v[76:77], v7 offset:4096
    ds_read_b64_tr_b16 v[78:79], v7 offset:5120
    v_mfma_f32_32x32x16_bf16 v[224:239], v[96:99], v[108:111], v[224:239]
    v_mfma_f32_32x32x16_bf16 v[208:223], v[100:103], v[104:107], v[208:223]
    v_mfma_f32_32x32x16_bf16 v[240:255], v[100:103], v[108:111], v[240:255]
    s_waitcnt lgkmcnt(0)
    s_barrier
    v_mfma_f32_32x32x16_bf16 v[128:143], v[64:67], v[80:83], v[128:143]
    ds_read_b128 v[104:107], v17 offset:21504
    ds_read_b128 v[108:111], v17 offset:54272
    v_mfma_f32_32x32x16_bf16 v[160:175], v[64:67], v[84:87], v[160:175]
    ds_read_b64_tr_b16 v[88:89], v6 offset:8192
    ds_read_b64_tr_b16 v[90:91], v6 offset:9216
    v_mfma_f32_32x32x16_bf16 v[144:159], v[68:71], v[80:83], v[144:159]
    ds_read_b64_tr_b16 v[92:93], v6 offset:12288
    ds_read_b64_tr_b16 v[94:95], v6 offset:13312
    v_mfma_f32_32x32x16_bf16 v[176:191], v[68:71], v[84:87], v[176:191]
    ds_read_b64_tr_b16 v[96:97], v7 offset:8192
    ds_read_b64_tr_b16 v[98:99], v7 offset:9216
    v_mfma_f32_32x32x16_bf16 v[192:207], v[72:75], v[80:83], v[192:207]
    ds_read_b64_tr_b16 v[100:101], v7 offset:12288
    ds_read_b64_tr_b16 v[102:103], v7 offset:13312
    v_mfma_f32_32x32x16_bf16 v[224:239], v[72:75], v[84:87], v[224:239]
    v_mfma_f32_32x32x16_bf16 v[208:223], v[76:79], v[80:83], v[208:223]
    v_mfma_f32_32x32x16_bf16 v[240:255], v[76:79], v[84:87], v[240:255]
    s_waitcnt lgkmcnt(0)
    s_barrier
    v_mfma_f32_32x32x16_bf16 v[128:143], v[88:91], v[104:107], v[128:143]
    ds_read_b128 v[80:83], v18 offset:22528
    ds_read_b128 v[84:87], v18 offset:55296
    v_mfma_f32_32x32x16_bf16 v[160:175], v[88:91], v[108:111], v[160:175]
    ds_read_b64_tr_b16 v[64:65], v6 offset:16384
    ds_read_b64_tr_b16 v[66:67], v6 offset:17408
    v_mfma_f32_32x32x16_bf16 v[144:159], v[92:95], v[104:107], v[144:159]
    ds_read_b64_tr_b16 v[68:69], v6 offset:20480
    ds_read_b64_tr_b16 v[70:71], v6 offset:21504
    v_mfma_f32_32x32x16_bf16 v[176:191], v[92:95], v[108:111], v[176:191]
    ds_read_b64_tr_b16 v[72:73], v7 offset:16384
    ds_read_b64_tr_b16 v[74:75], v7 offset:17408
    v_mfma_f32_32x32x16_bf16 v[192:207], v[96:99], v[104:107], v[192:207]
    ds_read_b64_tr_b16 v[76:77], v7 offset:20480
    ds_read_b64_tr_b16 v[78:79], v7 offset:21504
    v_mfma_f32_32x32x16_bf16 v[224:239], v[96:99], v[108:111], v[224:239]
    v_mfma_f32_32x32x16_bf16 v[208:223], v[100:103], v[104:107], v[208:223]
    v_mfma_f32_32x32x16_bf16 v[240:255], v[100:103], v[108:111], v[240:255]
    s_waitcnt lgkmcnt(0)
    s_barrier
    v_mfma_f32_32x32x16_bf16 v[128:143], v[64:67], v[80:83], v[128:143]
    ds_read_b128 v[104:107], v19 offset:23552
    ds_read_b128 v[108:111], v19 offset:56320
    v_mfma_f32_32x32x16_bf16 v[160:175], v[64:67], v[84:87], v[160:175]
    ds_read_b64_tr_b16 v[88:89], v6 offset:24576
    ds_read_b64_tr_b16 v[90:91], v6 offset:25600
    v_mfma_f32_32x32x16_bf16 v[144:159], v[68:71], v[80:83], v[144:159]
    ds_read_b64_tr_b16 v[92:93], v6 offset:28672
    ds_read_b64_tr_b16 v[94:95], v6 offset:29696
    v_mfma_f32_32x32x16_bf16 v[176:191], v[68:71], v[84:87], v[176:191]
    ds_read_b64_tr_b16 v[96:97], v7 offset:24576
    ds_read_b64_tr_b16 v[98:99], v7 offset:25600
    v_mfma_f32_32x32x16_bf16 v[192:207], v[72:75], v[80:83], v[192:207]
    ds_read_b64_tr_b16 v[100:101], v7 offset:28672
    ds_read_b64_tr_b16 v[102:103], v7 offset:29696
    v_mfma_f32_32x32x16_bf16 v[224:239], v[72:75], v[84:87], v[224:239]
    v_mfma_f32_32x32x16_bf16 v[208:223], v[76:79], v[80:83], v[208:223]
    v_mfma_f32_32x32x16_bf16 v[240:255], v[76:79], v[84:87], v[240:255]
    s_waitcnt lgkmcnt(0)
    s_barrier
    v_mfma_f32_32x32x16_bf16 v[128:143], v[88:91], v[104:107], v[128:143]
    ds_read_b128 v[80:83], v16 offset:24576
    ds_read_b128 v[84:87], v16 offset:57344
    v_mfma_f32_32x32x16_bf16 v[160:175], v[88:91], v[108:111], v[160:175]
    ds_read_b64_tr_b16 v[64:65], v6 offset:0
    ds_read_b64_tr_b16 v[66:67], v6 offset:1024
    v_mfma_f32_32x32x16_bf16 v[144:159], v[92:95], v[104:107], v[144:159]
    ds_read_b64_tr_b16 v[68:69], v6 offset:4096
    ds_read_b64_tr_b16 v[70:71], v6 offset:5120
    v_mfma_f32_32x32x16_bf16 v[176:191], v[92:95], v[108:111], v[176:191]
    ds_read_b64_tr_b16 v[72:73], v7 offset:0
    ds_read_b64_tr_b16 v[74:75], v7 offset:1024
    v_mfma_f32_32x32x16_bf16 v[192:207], v[96:99], v[104:107], v[192:207]
    ds_read_b64_tr_b16 v[76:77], v7 offset:4096
    ds_read_b64_tr_b16 v[78:79], v7 offset:5120
    v_mfma_f32_32x32x16_bf16 v[224:239], v[96:99], v[108:111], v[224:239]
    v_mfma_f32_32x32x16_bf16 v[208:223], v[100:103], v[104:107], v[208:223]
    v_mfma_f32_32x32x16_bf16 v[240:255], v[100:103], v[108:111], v[240:255]
    s_waitcnt lgkmcnt(0)
    s_barrier
    v_mfma_f32_32x32x16_bf16 v[128:143], v[64:67], v[80:83], v[128:143]
    ds_read_b128 v[104:107], v17 offset:25600
    ds_read_b128 v[108:111], v17 offset:58368
    v_mfma_f32_32x32x16_bf16 v[160:175], v[64:67], v[84:87], v[160:175]
    ds_read_b64_tr_b16 v[88:89], v6 offset:8192
    ds_read_b64_tr_b16 v[90:91], v6 offset:9216
    v_mfma_f32_32x32x16_bf16 v[144:159], v[68:71], v[80:83], v[144:159]
    ds_read_b64_tr_b16 v[92:93], v6 offset:12288
    ds_read_b64_tr_b16 v[94:95], v6 offset:13312
    v_mfma_f32_32x32x16_bf16 v[176:191], v[68:71], v[84:87], v[176:191]
    ds_read_b64_tr_b16 v[96:97], v7 offset:8192
    ds_read_b64_tr_b16 v[98:99], v7 offset:9216
    v_mfma_f32_32x32x16_bf16 v[192:207], v[72:75], v[80:83], v[192:207]
    ds_read_b64_tr_b16 v[100:101], v7 offset:12288
    ds_read_b64_tr_b16 v[102:103], v7 offset:13312
    v_mfma_f32_32x32x16_bf16 v[224:239], v[72:75], v[84:87], v[224:239]
    v_mfma_f32_32x32x16_bf16 v[208:223], v[76:79], v[80:83], v[208:223]
    v_mfma_f32_32x32x16_bf16 v[240:255], v[76:79], v[84:87], v[240:255]
    s_waitcnt lgkmcnt(0)
    s_barrier
    v_mfma_f32_32x32x16_bf16 v[128:143], v[88:91], v[104:107], v[128:143]
    ds_read_b128 v[80:83], v18 offset:26624
    ds_read_b128 v[84:87], v18 offset:59392
    v_mfma_f32_32x32x16_bf16 v[160:175], v[88:91], v[108:111], v[160:175]
    ds_read_b64_tr_b16 v[64:65], v6 offset:16384
    ds_read_b64_tr_b16 v[66:67], v6 offset:17408
    v_mfma_f32_32x32x16_bf16 v[144:159], v[92:95], v[104:107], v[144:159]
    ds_read_b64_tr_b16 v[68:69], v6 offset:20480
    ds_read_b64_tr_b16 v[70:71], v6 offset:21504
    v_mfma_f32_32x32x16_bf16 v[176:191], v[92:95], v[108:111], v[176:191]
    ds_read_b64_tr_b16 v[72:73], v7 offset:16384
    ds_read_b64_tr_b16 v[74:75], v7 offset:17408
    v_mfma_f32_32x32x16_bf16 v[192:207], v[96:99], v[104:107], v[192:207]
    ds_read_b64_tr_b16 v[76:77], v7 offset:20480
    ds_read_b64_tr_b16 v[78:79], v7 offset:21504
    v_mfma_f32_32x32x16_bf16 v[224:239], v[96:99], v[108:111], v[224:239]
    v_mfma_f32_32x32x16_bf16 v[208:223], v[100:103], v[104:107], v[208:223]
    v_mfma_f32_32x32x16_bf16 v[240:255], v[100:103], v[108:111], v[240:255]
    s_waitcnt lgkmcnt(0)
    s_barrier
    v_mfma_f32_32x32x16_bf16 v[128:143], v[64:67], v[80:83], v[128:143]
    ds_read_b128 v[104:107], v19 offset:27648
    ds_read_b128 v[108:111], v19 offset:60416
    v_mfma_f32_32x32x16_bf16 v[160:175], v[64:67], v[84:87], v[160:175]
    ds_read_b64_tr_b16 v[88:89], v6 offset:24576
    ds_read_b64_tr_b16 v[90:91], v6 offset:25600
    v_mfma_f32_32x32x16_bf16 v[144:159], v[68:71], v[80:83], v[144:159]
    ds_read_b64_tr_b16 v[92:93], v6 offset:28672
    ds_read_b64_tr_b16 v[94:95], v6 offset:29696
    v_mfma_f32_32x32x16_bf16 v[176:191], v[68:71], v[84:87], v[176:191]
    ds_read_b64_tr_b16 v[96:97], v7 offset:24576
    ds_read_b64_tr_b16 v[98:99], v7 offset:25600
    v_mfma_f32_32x32x16_bf16 v[192:207], v[72:75], v[80:83], v[192:207]
    ds_read_b64_tr_b16 v[100:101], v7 offset:28672
    ds_read_b64_tr_b16 v[102:103], v7 offset:29696
    v_mfma_f32_32x32x16_bf16 v[224:239], v[72:75], v[84:87], v[224:239]
    v_mfma_f32_32x32x16_bf16 v[208:223], v[76:79], v[80:83], v[208:223]
    v_mfma_f32_32x32x16_bf16 v[240:255], v[76:79], v[84:87], v[240:255]
    s_waitcnt lgkmcnt(0)
    s_barrier
    v_mfma_f32_32x32x16_bf16 v[128:143], v[88:91], v[104:107], v[128:143]
    ds_read_b128 v[80:83], v16 offset:28672
    ds_read_b128 v[84:87], v16 offset:61440
    v_mfma_f32_32x32x16_bf16 v[160:175], v[88:91], v[108:111], v[160:175]
    ds_read_b64_tr_b16 v[64:65], v6 offset:0
    ds_read_b64_tr_b16 v[66:67], v6 offset:1024
    v_mfma_f32_32x32x16_bf16 v[144:159], v[92:95], v[104:107], v[144:159]
    ds_read_b64_tr_b16 v[68:69], v6 offset:4096
    ds_read_b64_tr_b16 v[70:71], v6 offset:5120
    v_mfma_f32_32x32x16_bf16 v[176:191], v[92:95], v[108:111], v[176:191]
    ds_read_b64_tr_b16 v[72:73], v7 offset:0
    ds_read_b64_tr_b16 v[74:75], v7 offset:1024
    v_mfma_f32_32x32x16_bf16 v[192:207], v[96:99], v[104:107], v[192:207]
    ds_read_b64_tr_b16 v[76:77], v7 offset:4096
    ds_read_b64_tr_b16 v[78:79], v7 offset:5120
    v_mfma_f32_32x32x16_bf16 v[224:239], v[96:99], v[108:111], v[224:239]
    v_mfma_f32_32x32x16_bf16 v[208:223], v[100:103], v[104:107], v[208:223]
    v_mfma_f32_32x32x16_bf16 v[240:255], v[100:103], v[108:111], v[240:255]
    s_waitcnt lgkmcnt(0)
    s_barrier
    v_mfma_f32_32x32x16_bf16 v[128:143], v[64:67], v[80:83], v[128:143]
    ds_read_b128 v[104:107], v17 offset:29696
    ds_read_b128 v[108:111], v17 offset:62464
    v_mfma_f32_32x32x16_bf16 v[160:175], v[64:67], v[84:87], v[160:175]
    ds_read_b64_tr_b16 v[88:89], v6 offset:8192
    ds_read_b64_tr_b16 v[90:91], v6 offset:9216
    v_mfma_f32_32x32x16_bf16 v[144:159], v[68:71], v[80:83], v[144:159]
    ds_read_b64_tr_b16 v[92:93], v6 offset:12288
    ds_read_b64_tr_b16 v[94:95], v6 offset:13312
    v_mfma_f32_32x32x16_bf16 v[176:191], v[68:71], v[84:87], v[176:191]
    ds_read_b64_tr_b16 v[96:97], v7 offset:8192
    ds_read_b64_tr_b16 v[98:99], v7 offset:9216
    v_mfma_f32_32x32x16_bf16 v[192:207], v[72:75], v[80:83], v[192:207]
    ds_read_b64_tr_b16 v[100:101], v7 offset:12288
    ds_read_b64_tr_b16 v[102:103], v7 offset:13312
    v_mfma_f32_32x32x16_bf16 v[224:239], v[72:75], v[84:87], v[224:239]
    v_mfma_f32_32x32x16_bf16 v[208:223], v[76:79], v[80:83], v[208:223]
    v_mfma_f32_32x32x16_bf16 v[240:255], v[76:79], v[84:87], v[240:255]
    s_waitcnt lgkmcnt(0)
    s_barrier
    v_mfma_f32_32x32x16_bf16 v[128:143], v[88:91], v[104:107], v[128:143]
    ds_read_b128 v[80:83], v18 offset:30720
    ds_read_b128 v[84:87], v18 offset:63488
    v_mfma_f32_32x32x16_bf16 v[160:175], v[88:91], v[108:111], v[160:175]
    ds_read_b64_tr_b16 v[64:65], v6 offset:16384
    ds_read_b64_tr_b16 v[66:67], v6 offset:17408
    v_mfma_f32_32x32x16_bf16 v[144:159], v[92:95], v[104:107], v[144:159]
    ds_read_b64_tr_b16 v[68:69], v6 offset:20480
    ds_read_b64_tr_b16 v[70:71], v6 offset:21504
    v_mfma_f32_32x32x16_bf16 v[176:191], v[92:95], v[108:111], v[176:191]
    ds_read_b64_tr_b16 v[72:73], v7 offset:16384
    ds_read_b64_tr_b16 v[74:75], v7 offset:17408
    v_mfma_f32_32x32x16_bf16 v[192:207], v[96:99], v[104:107], v[192:207]
    ds_read_b64_tr_b16 v[76:77], v7 offset:20480
    ds_read_b64_tr_b16 v[78:79], v7 offset:21504
    v_mfma_f32_32x32x16_bf16 v[224:239], v[96:99], v[108:111], v[224:239]
    v_mfma_f32_32x32x16_bf16 v[208:223], v[100:103], v[104:107], v[208:223]
    v_mfma_f32_32x32x16_bf16 v[240:255], v[100:103], v[108:111], v[240:255]
    s_waitcnt lgkmcnt(0)
    s_barrier
    v_mfma_f32_32x32x16_bf16 v[128:143], v[64:67], v[80:83], v[128:143]
    ds_read_b128 v[104:107], v19 offset:31744
    ds_read_b128 v[108:111], v19 offset:64512
    v_mfma_f32_32x32x16_bf16 v[160:175], v[64:67], v[84:87], v[160:175]
    ds_read_b64_tr_b16 v[88:89], v6 offset:24576
    ds_read_b64_tr_b16 v[90:91], v6 offset:25600
    v_mfma_f32_32x32x16_bf16 v[144:159], v[68:71], v[80:83], v[144:159]
    ds_read_b64_tr_b16 v[92:93], v6 offset:28672
    ds_read_b64_tr_b16 v[94:95], v6 offset:29696
    v_mfma_f32_32x32x16_bf16 v[176:191], v[68:71], v[84:87], v[176:191]
    ds_read_b64_tr_b16 v[96:97], v7 offset:24576
    ds_read_b64_tr_b16 v[98:99], v7 offset:25600
    v_mfma_f32_32x32x16_bf16 v[192:207], v[72:75], v[80:83], v[192:207]
    ds_read_b64_tr_b16 v[100:101], v7 offset:28672
    ds_read_b64_tr_b16 v[102:103], v7 offset:29696
    v_mfma_f32_32x32x16_bf16 v[224:239], v[72:75], v[84:87], v[224:239]
    v_mfma_f32_32x32x16_bf16 v[208:223], v[76:79], v[80:83], v[208:223]
    v_mfma_f32_32x32x16_bf16 v[240:255], v[76:79], v[84:87], v[240:255]
    s_waitcnt lgkmcnt(0)
    v_mfma_f32_32x32x16_bf16 v[128:143], v[88:91], v[104:107], v[128:143]
    v_mfma_f32_32x32x16_bf16 v[160:175], v[88:91], v[108:111], v[160:175]
    v_mfma_f32_32x32x16_bf16 v[144:159], v[92:95], v[104:107], v[144:159]
    v_mfma_f32_32x32x16_bf16 v[176:191], v[92:95], v[108:111], v[176:191]
    v_mfma_f32_32x32x16_bf16 v[192:207], v[96:99], v[104:107], v[192:207]
    v_mfma_f32_32x32x16_bf16 v[224:239], v[96:99], v[108:111], v[224:239]
    v_mfma_f32_32x32x16_bf16 v[208:223], v[100:103], v[104:107], v[208:223]
    v_mfma_f32_32x32x16_bf16 v[240:255], v[100:103], v[108:111], v[240:255]
    s_setprio 0
    s_nop 7
    s_nop 7
    s_lshl_b32 s10, s6, 2
    s_lshl_b32 s11, s9, 1
    s_add_u32 s10, s10, s11
    s_mul_i32 s10, s10, 112
    s_lshl_b32 s11, s7, 3
    s_add_u32 s10, s10, s11
    s_lshl_b32 s11, s8, 2
    s_add_u32 s10, s10, s11
    s_lshl_b32 s10, s10, 10
    s_add_u32 s10, s10, 0
    s_add_u32 s11, s10, 114688
    v_lshlrev_b32 v8, 4, v1
    v_max_f32 v128, 0, v128
    v_max_f32 v129, 0, v129
    v_max_f32 v130, 0, v130
    v_max_f32 v131, 0, v131
    v_max_f32 v132, 0, v132
    v_max_f32 v133, 0, v133
    v_max_f32 v134, 0, v134
    v_max_f32 v135, 0, v135
    v_max_f32 v136, 0, v136
    v_max_f32 v137, 0, v137
    v_max_f32 v138, 0, v138
    v_max_f32 v139, 0, v139
    v_max_f32 v140, 0, v140
    v_max_f32 v141, 0, v141
    v_max_f32 v142, 0, v142
    v_max_f32 v143, 0, v143
    v_pk_mul_f32 v[128:129], v[128:129], v[144:145]
    v_pk_mul_f32 v[130:131], v[130:131], v[146:147]
    v_pk_mul_f32 v[132:133], v[132:133], v[148:149]
    v_pk_mul_f32 v[134:135], v[134:135], v[150:151]
    v_pk_mul_f32 v[136:137], v[136:137], v[152:153]
    v_pk_mul_f32 v[138:139], v[138:139], v[154:155]
    v_pk_mul_f32 v[140:141], v[140:141], v[156:157]
    v_pk_mul_f32 v[142:143], v[142:143], v[158:159]
    v_cvt_pk_bf16_f32 v144, v128, v129
    v_cvt_pk_bf16_f32 v145, v130, v131
    v_cvt_pk_bf16_f32 v146, v132, v133
    v_cvt_pk_bf16_f32 v147, v134, v135
    v_cvt_pk_bf16_f32 v148, v136, v137
    v_cvt_pk_bf16_f32 v149, v138, v139
    v_cvt_pk_bf16_f32 v150, v140, v141
    v_cvt_pk_bf16_f32 v151, v142, v143
    buffer_store_dwordx4 v[144:147], v8, s[40:43], s10 offen offset:0
    buffer_store_dwordx4 v[148:151], v8, s[40:43], s10 offen offset:1024
    v_max_f32 v192, 0, v192
    v_max_f32 v193, 0, v193
    v_max_f32 v194, 0, v194
    v_max_f32 v195, 0, v195
    v_max_f32 v196, 0, v196
    v_max_f32 v197, 0, v197
    v_max_f32 v198, 0, v198
    v_max_f32 v199, 0, v199
    v_max_f32 v200, 0, v200
    v_max_f32 v201, 0, v201
    v_max_f32 v202, 0, v202
    v_max_f32 v203, 0, v203
    v_max_f32 v204, 0, v204
    v_max_f32 v205, 0, v205
    v_max_f32 v206, 0, v206
    v_max_f32 v207, 0, v207
    v_pk_mul_f32 v[192:193], v[192:193], v[208:209]
    v_pk_mul_f32 v[194:195], v[194:195], v[210:211]
    v_pk_mul_f32 v[196:197], v[196:197], v[212:213]
    v_pk_mul_f32 v[198:199], v[198:199], v[214:215]
    v_pk_mul_f32 v[200:201], v[200:201], v[216:217]
    v_pk_mul_f32 v[202:203], v[202:203], v[218:219]
    v_pk_mul_f32 v[204:205], v[204:205], v[220:221]
    v_pk_mul_f32 v[206:207], v[206:207], v[222:223]
    v_cvt_pk_bf16_f32 v208, v192, v193
    v_cvt_pk_bf16_f32 v209, v194, v195
    v_cvt_pk_bf16_f32 v210, v196, v197
    v_cvt_pk_bf16_f32 v211, v198, v199
    v_cvt_pk_bf16_f32 v212, v200, v201
    v_cvt_pk_bf16_f32 v213, v202, v203
    v_cvt_pk_bf16_f32 v214, v204, v205
    v_cvt_pk_bf16_f32 v215, v206, v207
    buffer_store_dwordx4 v[208:211], v8, s[40:43], s10 offen offset:2048
    buffer_store_dwordx4 v[212:215], v8, s[40:43], s10 offen offset:3072
    v_max_f32 v160, 0, v160
    v_max_f32 v161, 0, v161
    v_max_f32 v162, 0, v162
    v_max_f32 v163, 0, v163
    v_max_f32 v164, 0, v164
    v_max_f32 v165, 0, v165
    v_max_f32 v166, 0, v166
    v_max_f32 v167, 0, v167
    v_max_f32 v168, 0, v168
    v_max_f32 v169, 0, v169
    v_max_f32 v170, 0, v170
    v_max_f32 v171, 0, v171
    v_max_f32 v172, 0, v172
    v_max_f32 v173, 0, v173
    v_max_f32 v174, 0, v174
    v_max_f32 v175, 0, v175
    v_pk_mul_f32 v[160:161], v[160:161], v[176:177]
    v_pk_mul_f32 v[162:163], v[162:163], v[178:179]
    v_pk_mul_f32 v[164:165], v[164:165], v[180:181]
    v_pk_mul_f32 v[166:167], v[166:167], v[182:183]
    v_pk_mul_f32 v[168:169], v[168:169], v[184:185]
    v_pk_mul_f32 v[170:171], v[170:171], v[186:187]
    v_pk_mul_f32 v[172:173], v[172:173], v[188:189]
    v_pk_mul_f32 v[174:175], v[174:175], v[190:191]
    v_cvt_pk_bf16_f32 v176, v160, v161
    v_cvt_pk_bf16_f32 v177, v162, v163
    v_cvt_pk_bf16_f32 v178, v164, v165
    v_cvt_pk_bf16_f32 v179, v166, v167
    v_cvt_pk_bf16_f32 v180, v168, v169
    v_cvt_pk_bf16_f32 v181, v170, v171
    v_cvt_pk_bf16_f32 v182, v172, v173
    v_cvt_pk_bf16_f32 v183, v174, v175
    buffer_store_dwordx4 v[176:179], v8, s[40:43], s11 offen offset:0
    buffer_store_dwordx4 v[180:183], v8, s[40:43], s11 offen offset:1024
    v_max_f32 v224, 0, v224
    v_max_f32 v225, 0, v225
    v_max_f32 v226, 0, v226
    v_max_f32 v227, 0, v227
    v_max_f32 v228, 0, v228
    v_max_f32 v229, 0, v229
    v_max_f32 v230, 0, v230
    v_max_f32 v231, 0, v231
    v_max_f32 v232, 0, v232
    v_max_f32 v233, 0, v233
    v_max_f32 v234, 0, v234
    v_max_f32 v235, 0, v235
    v_max_f32 v236, 0, v236
    v_max_f32 v237, 0, v237
    v_max_f32 v238, 0, v238
    v_max_f32 v239, 0, v239
    v_pk_mul_f32 v[224:225], v[224:225], v[240:241]
    v_pk_mul_f32 v[226:227], v[226:227], v[242:243]
    v_pk_mul_f32 v[228:229], v[228:229], v[244:245]
    v_pk_mul_f32 v[230:231], v[230:231], v[246:247]
    v_pk_mul_f32 v[232:233], v[232:233], v[248:249]
    v_pk_mul_f32 v[234:235], v[234:235], v[250:251]
    v_pk_mul_f32 v[236:237], v[236:237], v[252:253]
    v_pk_mul_f32 v[238:239], v[238:239], v[254:255]
    v_cvt_pk_bf16_f32 v240, v224, v225
    v_cvt_pk_bf16_f32 v241, v226, v227
    v_cvt_pk_bf16_f32 v242, v228, v229
    v_cvt_pk_bf16_f32 v243, v230, v231
    v_cvt_pk_bf16_f32 v244, v232, v233
    v_cvt_pk_bf16_f32 v245, v234, v235
    v_cvt_pk_bf16_f32 v246, v236, v237
    v_cvt_pk_bf16_f32 v247, v238, v239
    buffer_store_dwordx4 v[240:243], v8, s[40:43], s11 offen offset:2048
    buffer_store_dwordx4 v[244:247], v8, s[40:43], s11 offen offset:3072
    s_branch K1_FIN
K1_STAGE1:
    s_sub_u32 s4, s2, 224
    s_and_b32 s5, s4, 1
    s_lshr_b32 s6, s4, 1
    s_lshl_b32 s8, s6, 5
    s_lshl_b32 s9, s3, 2
    s_add_u32 s8, s8, s9
    v_add_u32 v6, s8, v2
    v_cmp_eq_u32 vcc, 0, v6
    v_sub_u32 v7, 2048, v6
    v_mov_b32 v8, 512
    v_cndmask_b32 v7, v7, v8, vcc
    v_sub_u32 v8, 1024, v6
    v_add_u32 v9, 1024, v6
    v_mov_b32 v10, 1536
    v_cndmask_b32 v9, v9, v10, vcc
    v_lshlrev_b32 v10, 4, v3
    v_lshl_add_u32 v34, v6, 10, v10
    v_lshl_add_u32 v35, v7, 10, v10
    v_lshl_add_u32 v36, v8, 10, v10
    v_lshl_add_u32 v37, v9, 10, v10
    s_mov_b64 s[68:69], vcc
    s_waitcnt lgkmcnt(0)
    s_mov_b32 s36, s16
    s_and_b32 s37, s17, 0xffff
    s_mov_b32 s38, 0x200000
    s_mov_b32 s39, 0x20000
    buffer_load_dwordx4 v[192:195], v34, s[36:39], 0 offen offset:0
    buffer_load_dwordx4 v[196:199], v34, s[36:39], 0 offen offset:256
    buffer_load_dwordx4 v[200:203], v34, s[36:39], 0 offen offset:512
    buffer_load_dwordx4 v[204:207], v34, s[36:39], 0 offen offset:768
    buffer_load_dwordx4 v[208:211], v35, s[36:39], 0 offen offset:0
    buffer_load_dwordx4 v[212:215], v35, s[36:39], 0 offen offset:256
    buffer_load_dwordx4 v[216:219], v35, s[36:39], 0 offen offset:512
    buffer_load_dwordx4 v[220:223], v35, s[36:39], 0 offen offset:768
    buffer_load_dwordx4 v[224:227], v36, s[36:39], 0 offen offset:0
    buffer_load_dwordx4 v[228:231], v36, s[36:39], 0 offen offset:256
    buffer_load_dwordx4 v[232:235], v36, s[36:39], 0 offen offset:512
    buffer_load_dwordx4 v[236:239], v36, s[36:39], 0 offen offset:768
    buffer_load_dwordx4 v[240:243], v37, s[36:39], 0 offen offset:0
    buffer_load_dwordx4 v[244:247], v37, s[36:39], 0 offen offset:256
    buffer_load_dwordx4 v[248:251], v37, s[36:39], 0 offen offset:512
    buffer_load_dwordx4 v[252:255], v37, s[36:39], 0 offen offset:768
    s_mov_b32 s40, s66
    s_and_b32 s41, s67, 0xffff
    s_mov_b32 s42, 0xc00000
    s_mov_b32 s43, 0x20000
    s_mov_b32 s56, s32
    s_and_b32 s57, s33, 0xffff
    s_mov_b32 s58, 0x1c0000
    s_mov_b32 s59, 0x20000
    s_cmp_lt_u32 s2, 128
    s_cselect_b32 s52, s18, s20
    s_cselect_b32 s53, s19, s21
    s_and_b32 s53, s53, 0xffff
    s_mov_b32 s54, 0x800000
    s_mov_b32 s55, 0x20000
    s_waitcnt vmcnt(12)
    v_dot2_f32_bf16 v24, v192, v38, 0
    v_dot2_f32_bf16 v25, v192, v192, 0
    v_dot2_f32_bf16 v32, v193, v38, 0
    v_dot2_f32_bf16 v33, v193, v193, 0
    v_dot2_f32_bf16 v24, v194, v38, v24
    v_dot2_f32_bf16 v25, v194, v194, v25
    v_dot2_f32_bf16 v32, v195, v38, v32
    v_dot2_f32_bf16 v33, v195, v195, v33
    v_dot2_f32_bf16 v24, v196, v38, v24
    v_dot2_f32_bf16 v25, v196, v196, v25
    v_dot2_f32_bf16 v32, v197, v38, v32
    v_dot2_f32_bf16 v33, v197, v197, v33
    v_dot2_f32_bf16 v24, v198, v38, v24
    v_dot2_f32_bf16 v25, v198, v198, v25
    v_dot2_f32_bf16 v32, v199, v38, v32
    v_dot2_f32_bf16 v33, v199, v199, v33
    v_dot2_f32_bf16 v24, v200, v38, v24
    v_dot2_f32_bf16 v25, v200, v200, v25
    v_dot2_f32_bf16 v32, v201, v38, v32
    v_dot2_f32_bf16 v33, v201, v201, v33
    v_dot2_f32_bf16 v24, v202, v38, v24
    v_dot2_f32_bf16 v25, v202, v202, v25
    v_dot2_f32_bf16 v32, v203, v38, v32
    v_dot2_f32_bf16 v33, v203, v203, v33
    v_dot2_f32_bf16 v24, v204, v38, v24
    v_dot2_f32_bf16 v25, v204, v204, v25
    v_dot2_f32_bf16 v32, v205, v38, v32
    v_dot2_f32_bf16 v33, v205, v205, v33
    v_dot2_f32_bf16 v24, v206, v38, v24
    v_dot2_f32_bf16 v25, v206, v206, v25
    v_dot2_f32_bf16 v32, v207, v38, v32
    v_dot2_f32_bf16 v33, v207, v207, v33
    v_lshlrev_b32 v64, 16, v192
    v_and_b32 v65, s60, v192
    v_lshlrev_b32 v66, 16, v193
    v_and_b32 v67, s60, v193
    v_lshlrev_b32 v68, 16, v194
    v_and_b32 v69, s60, v194
    v_lshlrev_b32 v70, 16, v195
    v_and_b32 v71, s60, v195
    v_lshlrev_b32 v72, 16, v196
    v_and_b32 v73, s60, v196
    v_lshlrev_b32 v74, 16, v197
    v_and_b32 v75, s60, v197
    v_lshlrev_b32 v76, 16, v198
    v_and_b32 v77, s60, v198
    v_lshlrev_b32 v78, 16, v199
    v_and_b32 v79, s60, v199
    v_lshlrev_b32 v80, 16, v200
    v_and_b32 v81, s60, v200
    v_lshlrev_b32 v82, 16, v201
    v_and_b32 v83, s60, v201
    v_lshlrev_b32 v84, 16, v202
    v_and_b32 v85, s60, v202
    v_lshlrev_b32 v86, 16, v203
    v_and_b32 v87, s60, v203
    v_lshlrev_b32 v88, 16, v204
    v_and_b32 v89, s60, v204
    v_lshlrev_b32 v90, 16, v205
    v_and_b32 v91, s60, v205
    v_lshlrev_b32 v92, 16, v206
    v_and_b32 v93, s60, v206
    v_lshlrev_b32 v94, 16, v207
    v_and_b32 v95, s60, v207
    v_add_f32 v24, v24, v32
    v_add_f32 v25, v25, v33
    s_waitcnt vmcnt(8)
    v_dot2_f32_bf16 v26, v208, v38, 0
    v_dot2_f32_bf16 v27, v208, v208, 0
    v_dot2_f32_bf16 v34, v209, v38, 0
    v_dot2_f32_bf16 v35, v209, v209, 0
    v_dot2_f32_bf16 v26, v210, v38, v26
    v_dot2_f32_bf16 v27, v210, v210, v27
    v_dot2_f32_bf16 v34, v211, v38, v34
    v_dot2_f32_bf16 v35, v211, v211, v35
    v_dot2_f32_bf16 v26, v212, v38, v26
    v_dot2_f32_bf16 v27, v212, v212, v27
    v_dot2_f32_bf16 v34, v213, v38, v34
    v_dot2_f32_bf16 v35, v213, v213, v35
    v_dot2_f32_bf16 v26, v214, v38, v26
    v_dot2_f32_bf16 v27, v214, v214, v27
    v_dot2_f32_bf16 v34, v215, v38, v34
    v_dot2_f32_bf16 v35, v215, v215, v35
    v_dot2_f32_bf16 v26, v216, v38, v26
    v_dot2_f32_bf16 v27, v216, v216, v27
    v_dot2_f32_bf16 v34, v217, v38, v34
    v_dot2_f32_bf16 v35, v217, v217, v35
    v_dot2_f32_bf16 v26, v218, v38, v26
    v_dot2_f32_bf16 v27, v218, v218, v27
    v_dot2_f32_bf16 v34, v219, v38, v34
    v_dot2_f32_bf16 v35, v219, v219, v35
    v_dot2_f32_bf16 v26, v220, v38, v26
    v_dot2_f32_bf16 v27, v220, v220, v27
    v_dot2_f32_bf16 v34, v221, v38, v34
    v_dot2_f32_bf16 v35, v221, v221, v35
    v_dot2_f32_bf16 v26, v222, v38, v26
    v_dot2_f32_bf16 v27, v222, v222, v27
    v_dot2_f32_bf16 v34, v223, v38, v34
    v_dot2_f32_bf16 v35, v223, v223, v35
    v_lshlrev_b32 v96, 16, v208
    v_and_b32 v97, s60, v208
    v_lshlrev_b32 v98, 16, v209
    v_and_b32 v99, s60, v209
    v_lshlrev_b32 v100, 16, v210
    v_and_b32 v101, s60, v210
    v_lshlrev_b32 v102, 16, v211
    v_and_b32 v103, s60, v211
    v_lshlrev_b32 v104, 16, v212
    v_and_b32 v105, s60, v212
    v_lshlrev_b32 v106, 16, v213
    v_and_b32 v107, s60, v213
    v_lshlrev_b32 v108, 16, v214
    v_and_b32 v109, s60, v214
    v_lshlrev_b32 v110, 16, v215
    v_and_b32 v111, s60, v215
    v_lshlrev_b32 v112, 16, v216
    v_and_b32 v113, s60, v216
    v_lshlrev_b32 v114, 16, v217
    v_and_b32 v115, s60, v217
    v_lshlrev_b32 v116, 16, v218
    v_and_b32 v117, s60, v218
    v_lshlrev_b32 v118, 16, v219
    v_and_b32 v119, s60, v219
    v_lshlrev_b32 v120, 16, v220
    v_and_b32 v121, s60, v220
    v_lshlrev_b32 v122, 16, v221
    v_and_b32 v123, s60, v221
    v_lshlrev_b32 v124, 16, v222
    v_and_b32 v125, s60, v222
    v_lshlrev_b32 v126, 16, v223
    v_and_b32 v127, s60, v223
    v_add_f32 v26, v26, v34
    v_add_f32 v27, v27, v35
    v_add_f32_dpp v24, v24, v24 row_ror:8 row_mask:0xf bank_mask:0xf
    v_add_f32_dpp v25, v25, v25 row_ror:8 row_mask:0xf bank_mask:0xf
    v_add_f32_dpp v26, v26, v26 row_ror:8 row_mask:0xf bank_mask:0xf
    v_add_f32_dpp v27, v27, v27 row_ror:8 row_mask:0xf bank_mask:0xf
    v_add_f32_dpp v24, v24, v24 row_ror:4 row_mask:0xf bank_mask:0xf
    v_add_f32_dpp v25, v25, v25 row_ror:4 row_mask:0xf bank_mask:0xf
    v_add_f32_dpp v26, v26, v26 row_ror:4 row_mask:0xf bank_mask:0xf
    v_add_f32_dpp v27, v27, v27 row_ror:4 row_mask:0xf bank_mask:0xf
    v_add_f32_dpp v24, v24, v24 row_ror:2 row_mask:0xf bank_mask:0xf
    v_add_f32_dpp v25, v25, v25 row_ror:2 row_mask:0xf bank_mask:0xf
    v_add_f32_dpp v26, v26, v26 row_ror:2 row_mask:0xf bank_mask:0xf
    v_add_f32_dpp v27, v27, v27 row_ror:2 row_mask:0xf bank_mask:0xf
    v_add_f32_dpp v24, v24, v24 row_ror:1 row_mask:0xf bank_mask:0xf
    v_add_f32_dpp v25, v25, v25 row_ror:1 row_mask:0xf bank_mask:0xf
    v_add_f32_dpp v26, v26, v26 row_ror:1 row_mask:0xf bank_mask:0xf
    v_add_f32_dpp v27, v27, v27 row_ror:1 row_mask:0xf bank_mask:0xf
    v_mul_f32 v49, 0xbb000000, v24
    v_mul_f32 v51, 0xbb000000, v26
    v_fma_f32 v25, v25, s61, v39
    v_fma_f32 v27, v27, s61, v39
    v_fma_f32 v25, -v49, v49, v25
    v_fma_f32 v27, -v51, v51, v27
    v_max_f32 v25, v25, v39
    v_max_f32 v27, v27, v39
    s_nop 0
    v_rsq_f32 v40, v25
    v_rsq_f32 v42, v27
    s_nop 0
    v_mul_f32 v48, v49, v40
    v_mul_f32 v50, v51, v42
    s_cmp_eq_u32 s5, 0
    s_cselect_b32 s44, s22, s24
    s_cselect_b32 s45, s23, s25
    s_cselect_b64 s[64:65], -1, 0
    s_and_b32 s45, s45, 0xffff
    s_mov_b32 s46, 0x80000
    s_mov_b32 s47, 0x20000
    v_lshrrev_b32 v6, 2, v1
    v_and_b32 v7, 3, v1
    v_xor_b32 v7, v7, v2
    v_lshlrev_b32 v7, 4, v7
    v_lshl_add_u32 v21, v6, 10, v7
    v_mov_b32 v8, 256
    v_cmp_eq_u32 vcc, 0, v6
    s_and_b64 vcc, vcc, s[64:65]
    s_nop 1
    v_cndmask_b32 v8, v6, v8, vcc
    v_lshl_add_u32 v20, v8, 10, v7
    s_and_b32 s8, s3, 1
    s_cmp_eq_u32 s8, 0
    s_cselect_b64 s[64:65], -1, 0
    s_nop 0
    v_cndmask_b32 v22, v21, v20, s[64:65]
    s_lshr_b32 s9, s3, 1
    s_lshl_b32 s63, s9, 6
    s_lshl_b32 s10, s8, 17
    s_add_u32 s63, s63, s10
    s_lshl_b32 s62, s9, 14
    s_lshl_b32 s10, s8, 13
    s_add_u32 s62, s62, s10
    s_add_u32 s62, s62, 69632
    s_add_u32 m0, s62, 0
    s_add_u32 s8, s63, 0
    buffer_load_dwordx4 v22, s[44:47], s8 offen lds
    s_add_u32 m0, s62, 1024
    s_add_u32 s8, s63, 16384
    buffer_load_dwordx4 v21, s[44:47], s8 offen lds
    s_add_u32 m0, s62, 2048
    s_add_u32 s8, s63, 32768
    buffer_load_dwordx4 v21, s[44:47], s8 offen lds
    s_add_u32 m0, s62, 3072
    s_add_u32 s8, s63, 49152
    buffer_load_dwordx4 v21, s[44:47], s8 offen lds
    s_add_u32 m0, s62, 4096
    s_add_u32 s8, s63, 65536
    buffer_load_dwordx4 v21, s[44:47], s8 offen lds
    s_add_u32 m0, s62, 5120
    s_add_u32 s8, s63, 81920
    buffer_load_dwordx4 v21, s[44:47], s8 offen lds
    s_add_u32 m0, s62, 6144
    s_add_u32 s8, s63, 98304
    buffer_load_dwordx4 v21, s[44:47], s8 offen lds
    s_add_u32 m0, s62, 7168
    s_add_u32 s8, s63, 114688
    buffer_load_dwordx4 v21, s[44:47], s8 offen lds
    s_lshr_b32 s8, s4, 3
    s_and_b32 s8, s8, 3
    s_lshl_b32 s8, s8, 3
    s_add_u32 s8, s8, s3
    s_lshl_b32 s8, s8, 3
    v_lshrrev_b32 v6, 3, v1
    v_add_u32 v6, s8, v6
    v_and_b32 v7, 7, v1
    v_lshlrev_b32 v7, 7, v7
    v_lshl_add_u32 v6, v6, 10, v7
    buffer_load_dword v47, v6, s[44:47], 0 offen
    s_cmp_eq_u32 s70, 0
    s_cselect_b64 s[64:65], -1, 0
    s_lshl_b32 s8, s70, 16
    v_add_u32 v21, s8, v21
    v_cndmask_b32 v20, v21, v20, s[64:65]
    v_add_u32 v22, 32768, v21
    v_add_u32 v23, 49152, v21
    v_add_u32 v21, 16384, v21
    s_lshl_b32 s62, s70, 12
    s_add_u32 s62, s62, 69632
    s_mov_b32 s63, 256
    s_waitcnt vmcnt(13)
    v_dot2_f32_bf16 v28, v224, v38, 0
    v_dot2_f32_bf16 v29, v224, v224, 0
    v_dot2_f32_bf16 v32, v225, v38, 0
    v_dot2_f32_bf16 v33, v225, v225, 0
    v_dot2_f32_bf16 v28, v226, v38, v28
    v_dot2_f32_bf16 v29, v226, v226, v29
    v_dot2_f32_bf16 v32, v227, v38, v32
    v_dot2_f32_bf16 v33, v227, v227, v33
    v_dot2_f32_bf16 v28, v228, v38, v28
    v_dot2_f32_bf16 v29, v228, v228, v29
    v_dot2_f32_bf16 v32, v229, v38, v32
    v_dot2_f32_bf16 v33, v229, v229, v33
    v_dot2_f32_bf16 v28, v230, v38, v28
    v_dot2_f32_bf16 v29, v230, v230, v29
    v_dot2_f32_bf16 v32, v231, v38, v32
    v_dot2_f32_bf16 v33, v231, v231, v33
    v_dot2_f32_bf16 v28, v232, v38, v28
    v_dot2_f32_bf16 v29, v232, v232, v29
    v_dot2_f32_bf16 v32, v233, v38, v32
    v_dot2_f32_bf16 v33, v233, v233, v33
    v_dot2_f32_bf16 v28, v234, v38, v28
    v_dot2_f32_bf16 v29, v234, v234, v29
    v_dot2_f32_bf16 v32, v235, v38, v32
    v_dot2_f32_bf16 v33, v235, v235, v33
    v_dot2_f32_bf16 v28, v236, v38, v28
    v_dot2_f32_bf16 v29, v236, v236, v29
    v_dot2_f32_bf16 v32, v237, v38, v32
    v_dot2_f32_bf16 v33, v237, v237, v33
    v_dot2_f32_bf16 v28, v238, v38, v28
    v_dot2_f32_bf16 v29, v238, v238, v29
    v_dot2_f32_bf16 v32, v239, v38, v32
    v_dot2_f32_bf16 v33, v239, v239, v33
    v_lshlrev_b32 v128, 16, v224
    v_and_b32 v129, s60, v224
    v_lshlrev_b32 v130, 16, v225
    v_and_b32 v131, s60, v225
    v_lshlrev_b32 v132, 16, v226
    v_and_b32 v133, s60, v226
    v_lshlrev_b32 v134, 16, v227
    v_and_b32 v135, s60, v227
    v_lshlrev_b32 v136, 16, v228
    v_and_b32 v137, s60, v228
    v_lshlrev_b32 v138, 16, v229
    v_and_b32 v139, s60, v229
    v_lshlrev_b32 v140, 16, v230
    v_and_b32 v141, s60, v230
    v_lshlrev_b32 v142, 16, v231
    v_and_b32 v143, s60, v231
    v_lshlrev_b32 v144, 16, v232
    v_and_b32 v145, s60, v232
    v_lshlrev_b32 v146, 16, v233
    v_and_b32 v147, s60, v233
    v_lshlrev_b32 v148, 16, v234
    v_and_b32 v149, s60, v234
    v_lshlrev_b32 v150, 16, v235
    v_and_b32 v151, s60, v235
    v_lshlrev_b32 v152, 16, v236
    v_and_b32 v153, s60, v236
    v_lshlrev_b32 v154, 16, v237
    v_and_b32 v155, s60, v237
    v_lshlrev_b32 v156, 16, v238
    v_and_b32 v157, s60, v238
    v_lshlrev_b32 v158, 16, v239
    v_and_b32 v159, s60, v239
    v_add_f32 v28, v28, v32
    v_add_f32 v29, v29, v33
    s_waitcnt vmcnt(9)
    v_dot2_f32_bf16 v30, v240, v38, 0
    v_dot2_f32_bf16 v31, v240, v240, 0
    v_dot2_f32_bf16 v34, v241, v38, 0
    v_dot2_f32_bf16 v35, v241, v241, 0
    v_dot2_f32_bf16 v30, v242, v38, v30
    v_dot2_f32_bf16 v31, v242, v242, v31
    v_dot2_f32_bf16 v34, v243, v38, v34
    v_dot2_f32_bf16 v35, v243, v243, v35
    v_dot2_f32_bf16 v30, v244, v38, v30
    v_dot2_f32_bf16 v31, v244, v244, v31
    v_dot2_f32_bf16 v34, v245, v38, v34
    v_dot2_f32_bf16 v35, v245, v245, v35
    v_dot2_f32_bf16 v30, v246, v38, v30
    v_dot2_f32_bf16 v31, v246, v246, v31
    v_dot2_f32_bf16 v34, v247, v38, v34
    v_dot2_f32_bf16 v35, v247, v247, v35
    v_dot2_f32_bf16 v30, v248, v38, v30
    v_dot2_f32_bf16 v31, v248, v248, v31
    v_dot2_f32_bf16 v34, v249, v38, v34
    v_dot2_f32_bf16 v35, v249, v249, v35
    v_dot2_f32_bf16 v30, v250, v38, v30
    v_dot2_f32_bf16 v31, v250, v250, v31
    v_dot2_f32_bf16 v34, v251, v38, v34
    v_dot2_f32_bf16 v35, v251, v251, v35
    v_dot2_f32_bf16 v30, v252, v38, v30
    v_dot2_f32_bf16 v31, v252, v252, v31
    v_dot2_f32_bf16 v34, v253, v38, v34
    v_dot2_f32_bf16 v35, v253, v253, v35
    v_dot2_f32_bf16 v30, v254, v38, v30
    v_dot2_f32_bf16 v31, v254, v254, v31
    v_dot2_f32_bf16 v34, v255, v38, v34
    v_dot2_f32_bf16 v35, v255, v255, v35
    v_lshlrev_b32 v160, 16, v240
    v_and_b32 v161, s60, v240
    v_lshlrev_b32 v162, 16, v241
    v_and_b32 v163, s60, v241
    v_lshlrev_b32 v164, 16, v242
    v_and_b32 v165, s60, v242
    v_lshlrev_b32 v166, 16, v243
    v_and_b32 v167, s60, v243
    v_lshlrev_b32 v168, 16, v244
    v_and_b32 v169, s60, v244
    v_lshlrev_b32 v170, 16, v245
    v_and_b32 v171, s60, v245
    v_lshlrev_b32 v172, 16, v246
    v_and_b32 v173, s60, v246
    v_lshlrev_b32 v174, 16, v247
    v_and_b32 v175, s60, v247
    v_lshlrev_b32 v176, 16, v248
    v_and_b32 v177, s60, v248
    v_lshlrev_b32 v178, 16, v249
    v_and_b32 v179, s60, v249
    v_lshlrev_b32 v180, 16, v250
    v_and_b32 v181, s60, v250
    v_lshlrev_b32 v182, 16, v251
    v_and_b32 v183, s60, v251
    v_lshlrev_b32 v184, 16, v252
    v_and_b32 v185, s60, v252
    v_lshlrev_b32 v186, 16, v253
    v_and_b32 v187, s60, v253
    v_lshlrev_b32 v188, 16, v254
    v_and_b32 v189, s60, v254
    v_lshlrev_b32 v190, 16, v255
    v_and_b32 v191, s60, v255
    v_add_f32 v30, v30, v34
    v_add_f32 v31, v31, v35
    v_add_f32_dpp v28, v28, v28 row_ror:8 row_mask:0xf bank_mask:0xf
    v_add_f32_dpp v29, v29, v29 row_ror:8 row_mask:0xf bank_mask:0xf
    v_add_f32_dpp v30, v30, v30 row_ror:8 row_mask:0xf bank_mask:0xf
    v_add_f32_dpp v31, v31, v31 row_ror:8 row_mask:0xf bank_mask:0xf
    v_add_f32_dpp v28, v28, v28 row_ror:4 row_mask:0xf bank_mask:0xf
    v_add_f32_dpp v29, v29, v29 row_ror:4 row_mask:0xf bank_mask:0xf
    v_add_f32_dpp v30, v30, v30 row_ror:4 row_mask:0xf bank_mask:0xf
    v_add_f32_dpp v31, v31, v31 row_ror:4 row_mask:0xf bank_mask:0xf
    v_add_f32_dpp v28, v28, v28 row_ror:2 row_mask:0xf bank_mask:0xf
    v_add_f32_dpp v29, v29, v29 row_ror:2 row_mask:0xf bank_mask:0xf
    v_add_f32_dpp v30, v30, v30 row_ror:2 row_mask:0xf bank_mask:0xf
    v_add_f32_dpp v31, v31, v31 row_ror:2 row_mask:0xf bank_mask:0xf
    v_add_f32_dpp v28, v28, v28 row_ror:1 row_mask:0xf bank_mask:0xf
    v_add_f32_dpp v29, v29, v29 row_ror:1 row_mask:0xf bank_mask:0xf
    v_add_f32_dpp v30, v30, v30 row_ror:1 row_mask:0xf bank_mask:0xf
    v_add_f32_dpp v31, v31, v31 row_ror:1 row_mask:0xf bank_mask:0xf
    v_mul_f32 v53, 0xbb000000, v28
    v_mul_f32 v55, 0xbb000000, v30
    v_fma_f32 v29, v29, s61, v39
    v_fma_f32 v31, v31, s61, v39
    v_fma_f32 v29, -v53, v53, v29
    v_fma_f32 v31, -v55, v55, v31
    v_max_f32 v29, v29, v39
    v_max_f32 v31, v31, v39
    s_nop 0
    v_rsq_f32 v44, v29
    v_rsq_f32 v46, v31
    s_nop 0
    v_mul_f32 v52, v53, v44
    v_mul_f32 v54, v55, v46
    s_cmp_eq_u32 s5, 0
    s_cselect_b32 s8, 0x3f800000, 0xbf800000
    s_cselect_b32 s9, 0x3f800000, 0
    s_cselect_b32 s10, 0, 0x3f800000
    s_cselect_b32 s11, 0, 0xbf800000
    v_mov_b32 v6, 1.0
    v_mov_b32 v7, s9
    v_cndmask_b32 v6, v6, v7, s[68:69]
    v_mul_f32 v8, v6, v40
    v_mul_f32 v12, v6, v44
    v_mov_b32 v6, s8
    v_mov_b32 v7, s10
    v_cndmask_b32 v7, v6, v7, s[68:69]
    v_mul_f32 v10, v7, v42
    v_mov_b32 v7, s11
    v_cndmask_b32 v7, v6, v7, s[68:69]
    v_mul_f32 v14, v7, v46
    v_mul_f32 v56, v8, v49
    v_fma_f32 v56, v10, v51, v56
    v_mul_f32 v58, v12, v53
    v_fma_f32 v58, v14, v55, v58
    v_add_f32 v60, v50, v54
    s_lshl_b32 s8, s3, 2
    v_add_u32 v6, s8, v2
    v_and_b32 v7, 7, v3
    v_xor_b32 v6, v6, v7
    v_lshlrev_b32 v6, 4, v6
    v_lshrrev_b32 v7, 1, v3
    v_lshl_add_u32 v6, v7, 10, v6
    v_and_b32 v7, 1, v3
    v_lshl_add_u32 v16, v7, 9, v6
    v_lshlrev_b32 v17, 4, v3
    v_add_u32 v17, 65536, v17
    v_pk_fma_f32 v[18:19], v[96:97], v[42:43], v[60:61] op_sel_hi:[1,0,0]
    v_pk_fma_f32 v[18:19], v[160:161], v[46:47], v[18:19] op_sel_hi:[1,0,1]
    v_cvt_pk_bf16_f32 v192, v18, v19
    v_pk_fma_f32 v[18:19], v[98:99], v[42:43], v[60:61] op_sel_hi:[1,0,0]
    v_pk_fma_f32 v[18:19], v[162:163], v[46:47], v[18:19] op_sel_hi:[1,0,1]
    v_cvt_pk_bf16_f32 v193, v18, v19
    v_pk_fma_f32 v[18:19], v[100:101], v[42:43], v[60:61] op_sel_hi:[1,0,0]
    v_pk_fma_f32 v[18:19], v[164:165], v[46:47], v[18:19] op_sel_hi:[1,0,1]
    v_cvt_pk_bf16_f32 v194, v18, v19
    v_pk_fma_f32 v[18:19], v[102:103], v[42:43], v[60:61] op_sel_hi:[1,0,0]
    v_pk_fma_f32 v[18:19], v[166:167], v[46:47], v[18:19] op_sel_hi:[1,0,1]
    v_cvt_pk_bf16_f32 v195, v18, v19
    v_pk_fma_f32 v[18:19], v[104:105], v[42:43], v[60:61] op_sel_hi:[1,0,0]
    v_pk_fma_f32 v[18:19], v[168:169], v[46:47], v[18:19] op_sel_hi:[1,0,1]
    v_cvt_pk_bf16_f32 v196, v18, v19
    v_pk_fma_f32 v[18:19], v[106:107], v[42:43], v[60:61] op_sel_hi:[1,0,0]
    v_pk_fma_f32 v[18:19], v[170:171], v[46:47], v[18:19] op_sel_hi:[1,0,1]
    v_cvt_pk_bf16_f32 v197, v18, v19
    v_pk_fma_f32 v[18:19], v[108:109], v[42:43], v[60:61] op_sel_hi:[1,0,0]
    v_pk_fma_f32 v[18:19], v[172:173], v[46:47], v[18:19] op_sel_hi:[1,0,1]
    v_cvt_pk_bf16_f32 v198, v18, v19
    v_pk_fma_f32 v[18:19], v[110:111], v[42:43], v[60:61] op_sel_hi:[1,0,0]
    v_pk_fma_f32 v[18:19], v[174:175], v[46:47], v[18:19] op_sel_hi:[1,0,1]
    v_cvt_pk_bf16_f32 v199, v18, v19
    v_pk_fma_f32 v[18:19], v[112:113], v[42:43], v[60:61] op_sel_hi:[1,0,0]
    v_pk_fma_f32 v[18:19], v[176:177], v[46:47], v[18:19] op_sel_hi:[1,0,1]
    v_cvt_pk_bf16_f32 v200, v18, v19
    v_pk_fma_f32 v[18:19], v[114:115], v[42:43], v[60:61] op_sel_hi:[1,0,0]
    v_pk_fma_f32 v[18:19], v[178:179], v[46:47], v[18:19] op_sel_hi:[1,0,1]
    v_cvt_pk_bf16_f32 v201, v18, v19
    v_pk_fma_f32 v[18:19], v[116:117], v[42:43], v[60:61] op_sel_hi:[1,0,0]
    v_pk_fma_f32 v[18:19], v[180:181], v[46:47], v[18:19] op_sel_hi:[1,0,1]
    v_cvt_pk_bf16_f32 v202, v18, v19
    v_pk_fma_f32 v[18:19], v[118:119], v[42:43], v[60:61] op_sel_hi:[1,0,0]
    v_pk_fma_f32 v[18:19], v[182:183], v[46:47], v[18:19] op_sel_hi:[1,0,1]
    v_cvt_pk_bf16_f32 v203, v18, v19
    v_pk_fma_f32 v[18:19], v[120:121], v[42:43], v[60:61] op_sel_hi:[1,0,0]
    v_pk_fma_f32 v[18:19], v[184:185], v[46:47], v[18:19] op_sel_hi:[1,0,1]
    v_cvt_pk_bf16_f32 v204, v18, v19
    v_pk_fma_f32 v[18:19], v[122:123], v[42:43], v[60:61] op_sel_hi:[1,0,0]
    v_pk_fma_f32 v[18:19], v[186:187], v[46:47], v[18:19] op_sel_hi:[1,0,1]
    v_cvt_pk_bf16_f32 v205, v18, v19
    v_pk_fma_f32 v[18:19], v[124:125], v[42:43], v[60:61] op_sel_hi:[1,0,0]
    v_pk_fma_f32 v[18:19], v[188:189], v[46:47], v[18:19] op_sel_hi:[1,0,1]
    v_cvt_pk_bf16_f32 v206, v18, v19
    v_pk_fma_f32 v[18:19], v[126:127], v[42:43], v[60:61] op_sel_hi:[1,0,0]
    v_pk_fma_f32 v[18:19], v[190:191], v[46:47], v[18:19] op_sel_hi:[1,0,1]
    v_cvt_pk_bf16_f32 v207, v18, v19
    s_cmp_eq_u32 s3, 0
    s_cbranch_scc0 S1_NOX
    s_mov_b64 s[90:91], exec
    s_mov_b32 exec_lo, 0xffff
    s_mov_b32 exec_hi, 0
    ds_write_b128 v17, v[192:195] offset:0
    ds_write_b128 v17, v[196:199] offset:256
    ds_write_b128 v17, v[200:203] offset:512
    ds_write_b128 v17, v[204:207] offset:768
    s_mov_b64 exec, s[90:91]
S1_NOX:
    v_pk_fma_f32 v[64:65], v[64:65], v[8:9], v[56:57] op_sel_hi:[1,0,0]
    v_pk_fma_f32 v[128:129], v[128:129], v[12:13], v[58:59] op_sel_hi:[1,0,0]
    v_pk_fma_f32 v[64:65], v[96:97], v[10:11], v[64:65] op_sel_hi:[1,0,1]
    v_pk_fma_f32 v[128:129], v[160:161], v[14:15], v[128:129] op_sel_hi:[1,0,1]
    v_pk_add_f32 v[96:97], v[64:65], v[128:129]
    v_pk_add_f32 v[160:161], v[64:65], v[128:129] neg_lo:[0,1] neg_hi:[0,1]
    v_cvt_pk_bf16_f32 v208, v96, v97
    v_cvt_pk_bf16_f32 v224, v160, v161
    v_pk_fma_f32 v[66:67], v[66:67], v[8:9], v[56:57] op_sel_hi:[1,0,0]
    v_pk_fma_f32 v[130:131], v[130:131], v[12:13], v[58:59] op_sel_hi:[1,0,0]
    v_pk_fma_f32 v[66:67], v[98:99], v[10:11], v[66:67] op_sel_hi:[1,0,1]
    v_pk_fma_f32 v[130:131], v[162:163], v[14:15], v[130:131] op_sel_hi:[1,0,1]
    v_pk_add_f32 v[98:99], v[66:67], v[130:131]
    v_pk_add_f32 v[162:163], v[66:67], v[130:131] neg_lo:[0,1] neg_hi:[0,1]
    v_cvt_pk_bf16_f32 v209, v98, v99
    v_cvt_pk_bf16_f32 v225, v162, v163
    v_pk_fma_f32 v[68:69], v[68:69], v[8:9], v[56:57] op_sel_hi:[1,0,0]
    v_pk_fma_f32 v[132:133], v[132:133], v[12:13], v[58:59] op_sel_hi:[1,0,0]
    v_pk_fma_f32 v[68:69], v[100:101], v[10:11], v[68:69] op_sel_hi:[1,0,1]
    v_pk_fma_f32 v[132:133], v[164:165], v[14:15], v[132:133] op_sel_hi:[1,0,1]
    v_pk_add_f32 v[100:101], v[68:69], v[132:133]
    v_pk_add_f32 v[164:165], v[68:69], v[132:133] neg_lo:[0,1] neg_hi:[0,1]
    v_cvt_pk_bf16_f32 v210, v100, v101
    v_cvt_pk_bf16_f32 v226, v164, v165
    v_pk_fma_f32 v[70:71], v[70:71], v[8:9], v[56:57] op_sel_hi:[1,0,0]
    v_pk_fma_f32 v[134:135], v[134:135], v[12:13], v[58:59] op_sel_hi:[1,0,0]
    v_pk_fma_f32 v[70:71], v[102:103], v[10:11], v[70:71] op_sel_hi:[1,0,1]
    v_pk_fma_f32 v[134:135], v[166:167], v[14:15], v[134:135] op_sel_hi:[1,0,1]
    v_pk_add_f32 v[102:103], v[70:71], v[134:135]
    v_pk_add_f32 v[166:167], v[70:71], v[134:135] neg_lo:[0,1] neg_hi:[0,1]
    v_cvt_pk_bf16_f32 v211, v102, v103
    v_cvt_pk_bf16_f32 v227, v166, v167
    ds_write_b128 v16, v[208:211] offset:0
    ds_write_b128 v16, v[224:227] offset:32768
    v_pk_fma_f32 v[72:73], v[72:73], v[8:9], v[56:57] op_sel_hi:[1,0,0]
    v_pk_fma_f32 v[136:137], v[136:137], v[12:13], v[58:59] op_sel_hi:[1,0,0]
    v_pk_fma_f32 v[72:73], v[104:105], v[10:11], v[72:73] op_sel_hi:[1,0,1]
    v_pk_fma_f32 v[136:137], v[168:169], v[14:15], v[136:137] op_sel_hi:[1,0,1]
    v_pk_add_f32 v[104:105], v[72:73], v[136:137]
    v_pk_add_f32 v[168:169], v[72:73], v[136:137] neg_lo:[0,1] neg_hi:[0,1]
    v_cvt_pk_bf16_f32 v212, v104, v105
    v_cvt_pk_bf16_f32 v228, v168, v169
    v_pk_fma_f32 v[74:75], v[74:75], v[8:9], v[56:57] op_sel_hi:[1,0,0]
    v_pk_fma_f32 v[138:139], v[138:139], v[12:13], v[58:59] op_sel_hi:[1,0,0]
    v_pk_fma_f32 v[74:75], v[106:107], v[10:11], v[74:75] op_sel_hi:[1,0,1]
    v_pk_fma_f32 v[138:139], v[170:171], v[14:15], v[138:139] op_sel_hi:[1,0,1]
    v_pk_add_f32 v[106:107], v[74:75], v[138:139]
    v_pk_add_f32 v[170:171], v[74:75], v[138:139] neg_lo:[0,1] neg_hi:[0,1]
    v_cvt_pk_bf16_f32 v213, v106, v107
    v_cvt_pk_bf16_f32 v229, v170, v171
    v_pk_fma_f32 v[76:77], v[76:77], v[8:9], v[56:57] op_sel_hi:[1,0,0]
    v_pk_fma_f32 v[140:141], v[140:141], v[12:13], v[58:59] op_sel_hi:[1,0,0]
    v_pk_fma_f32 v[76:77], v[108:109], v[10:11], v[76:77] op_sel_hi:[1,0,1]
    v_pk_fma_f32 v[140:141], v[172:173], v[14:15], v[140:141] op_sel_hi:[1,0,1]
    v_pk_add_f32 v[108:109], v[76:77], v[140:141]
    v_pk_add_f32 v[172:173], v[76:77], v[140:141] neg_lo:[0,1] neg_hi:[0,1]
    v_cvt_pk_bf16_f32 v214, v108, v109
    v_cvt_pk_bf16_f32 v230, v172, v173
    v_pk_fma_f32 v[78:79], v[78:79], v[8:9], v[56:57] op_sel_hi:[1,0,0]
    v_pk_fma_f32 v[142:143], v[142:143], v[12:13], v[58:59] op_sel_hi:[1,0,0]
    v_pk_fma_f32 v[78:79], v[110:111], v[10:11], v[78:79] op_sel_hi:[1,0,1]
    v_pk_fma_f32 v[142:143], v[174:175], v[14:15], v[142:143] op_sel_hi:[1,0,1]
    v_pk_add_f32 v[110:111], v[78:79], v[142:143]
    v_pk_add_f32 v[174:175], v[78:79], v[142:143] neg_lo:[0,1] neg_hi:[0,1]
    v_cvt_pk_bf16_f32 v215, v110, v111
    v_cvt_pk_bf16_f32 v231, v174, v175
    ds_write_b128 v16, v[212:215] offset:8192
    ds_write_b128 v16, v[228:231] offset:40960
    v_pk_fma_f32 v[80:81], v[80:81], v[8:9], v[56:57] op_sel_hi:[1,0,0]
    v_pk_fma_f32 v[144:145], v[144:145], v[12:13], v[58:59] op_sel_hi:[1,0,0]
    v_pk_fma_f32 v[80:81], v[112:113], v[10:11], v[80:81] op_sel_hi:[1,0,1]
    v_pk_fma_f32 v[144:145], v[176:177], v[14:15], v[144:145] op_sel_hi:[1,0,1]
    v_pk_add_f32 v[112:113], v[80:81], v[144:145]
    v_pk_add_f32 v[176:177], v[80:81], v[144:145] neg_lo:[0,1] neg_hi:[0,1]
    v_cvt_pk_bf16_f32 v216, v112, v113
    v_cvt_pk_bf16_f32 v232, v176, v177
    v_pk_fma_f32 v[82:83], v[82:83], v[8:9], v[56:57] op_sel_hi:[1,0,0]
    v_pk_fma_f32 v[146:147], v[146:147], v[12:13], v[58:59] op_sel_hi:[1,0,0]
    v_pk_fma_f32 v[82:83], v[114:115], v[10:11], v[82:83] op_sel_hi:[1,0,1]
    v_pk_fma_f32 v[146:147], v[178:179], v[14:15], v[146:147] op_sel_hi:[1,0,1]
    v_pk_add_f32 v[114:115], v[82:83], v[146:147]
    v_pk_add_f32 v[178:179], v[82:83], v[146:147] neg_lo:[0,1] neg_hi:[0,1]
    v_cvt_pk_bf16_f32 v217, v114, v115
    v_cvt_pk_bf16_f32 v233, v178, v179
    v_pk_fma_f32 v[84:85], v[84:85], v[8:9], v[56:57] op_sel_hi:[1,0,0]
    v_pk_fma_f32 v[148:149], v[148:149], v[12:13], v[58:59] op_sel_hi:[1,0,0]
    v_pk_fma_f32 v[84:85], v[116:117], v[10:11], v[84:85] op_sel_hi:[1,0,1]
    v_pk_fma_f32 v[148:149], v[180:181], v[14:15], v[148:149] op_sel_hi:[1,0,1]
    v_pk_add_f32 v[116:117], v[84:85], v[148:149]
    v_pk_add_f32 v[180:181], v[84:85], v[148:149] neg_lo:[0,1] neg_hi:[0,1]
    v_cvt_pk_bf16_f32 v218, v116, v117
    v_cvt_pk_bf16_f32 v234, v180, v181
    v_pk_fma_f32 v[86:87], v[86:87], v[8:9], v[56:57] op_sel_hi:[1,0,0]
    v_pk_fma_f32 v[150:151], v[150:151], v[12:13], v[58:59] op_sel_hi:[1,0,0]
    v_pk_fma_f32 v[86:87], v[118:119], v[10:11], v[86:87] op_sel_hi:[1,0,1]
    v_pk_fma_f32 v[150:151], v[182:183], v[14:15], v[150:151] op_sel_hi:[1,0,1]
    v_pk_add_f32 v[118:119], v[86:87], v[150:151]
    v_pk_add_f32 v[182:183], v[86:87], v[150:151] neg_lo:[0,1] neg_hi:[0,1]
    v_cvt_pk_bf16_f32 v219, v118, v119
    v_cvt_pk_bf16_f32 v235, v182, v183
    ds_write_b128 v16, v[216:219] offset:16384
    ds_write_b128 v16, v[232:235] offset:49152
    v_pk_fma_f32 v[88:89], v[88:89], v[8:9], v[56:57] op_sel_hi:[1,0,0]
    v_pk_fma_f32 v[152:153], v[152:153], v[12:13], v[58:59] op_sel_hi:[1,0,0]
    v_pk_fma_f32 v[88:89], v[120:121], v[10:11], v[88:89] op_sel_hi:[1,0,1]
    v_pk_fma_f32 v[152:153], v[184:185], v[14:15], v[152:153] op_sel_hi:[1,0,1]
    v_pk_add_f32 v[120:121], v[88:89], v[152:153]
    v_pk_add_f32 v[184:185], v[88:89], v[152:153] neg_lo:[0,1] neg_hi:[0,1]
    v_cvt_pk_bf16_f32 v220, v120, v121
    v_cvt_pk_bf16_f32 v236, v184, v185
    v_pk_fma_f32 v[90:91], v[90:91], v[8:9], v[56:57] op_sel_hi:[1,0,0]
    v_pk_fma_f32 v[154:155], v[154:155], v[12:13], v[58:59] op_sel_hi:[1,0,0]
    v_pk_fma_f32 v[90:91], v[122:123], v[10:11], v[90:91] op_sel_hi:[1,0,1]
    v_pk_fma_f32 v[154:155], v[186:187], v[14:15], v[154:155] op_sel_hi:[1,0,1]
    v_pk_add_f32 v[122:123], v[90:91], v[154:155]
    v_pk_add_f32 v[186:187], v[90:91], v[154:155] neg_lo:[0,1] neg_hi:[0,1]
    v_cvt_pk_bf16_f32 v221, v122, v123
    v_cvt_pk_bf16_f32 v237, v186, v187
    v_pk_fma_f32 v[92:93], v[92:93], v[8:9], v[56:57] op_sel_hi:[1,0,0]
    v_pk_fma_f32 v[156:157], v[156:157], v[12:13], v[58:59] op_sel_hi:[1,0,0]
    v_pk_fma_f32 v[92:93], v[124:125], v[10:11], v[92:93] op_sel_hi:[1,0,1]
    v_pk_fma_f32 v[156:157], v[188:189], v[14:15], v[156:157] op_sel_hi:[1,0,1]
    v_pk_add_f32 v[124:125], v[92:93], v[156:157]
    v_pk_add_f32 v[188:189], v[92:93], v[156:157] neg_lo:[0,1] neg_hi:[0,1]
    v_cvt_pk_bf16_f32 v222, v124, v125
    v_cvt_pk_bf16_f32 v238, v188, v189
    v_pk_fma_f32 v[94:95], v[94:95], v[8:9], v[56:57] op_sel_hi:[1,0,0]
    v_pk_fma_f32 v[158:159], v[158:159], v[12:13], v[58:59] op_sel_hi:[1,0,0]
    v_pk_fma_f32 v[94:95], v[126:127], v[10:11], v[94:95] op_sel_hi:[1,0,1]
    v_pk_fma_f32 v[158:159], v[190:191], v[14:15], v[158:159] op_sel_hi:[1,0,1]
    v_pk_add_f32 v[126:127], v[94:95], v[158:159]
    v_pk_add_f32 v[190:191], v[94:95], v[158:159] neg_lo:[0,1] neg_hi:[0,1]
    v_cvt_pk_bf16_f32 v223, v126, v127
    v_cvt_pk_bf16_f32 v239, v190, v191
    ds_write_b128 v16, v[220:223] offset:24576
    ds_write_b128 v16, v[236:239] offset:57344
    s_waitcnt vmcnt(1)
    s_cmp_lt_u32 s3, 4
    s_cbranch_scc1 S1_CONS
    s_waitcnt lgkmcnt(0)
    s_barrier
    s_barrier
    s_add_u32 m0, s62, 0
    s_nop 0
    buffer_load_dwordx4 v20, s[44:47], s63 offen lds
    s_add_u32 m0, s62, 1024
    s_nop 0
    buffer_load_dwordx4 v21, s[44:47], s63 offen lds
    s_add_u32 m0, s62, 2048
    s_nop 0
    buffer_load_dwordx4 v22, s[44:47], s63 offen lds
    s_add_u32 m0, s62, 3072
    s_nop 0
    buffer_load_dwordx4 v23, s[44:47], s63 offen lds
    s_add_u32 s63, s63, 64
    s_barrier
    s_add_u32 m0, s62, 16384
    s_nop 0
    buffer_load_dwordx4 v20, s[44:47], s63 offen lds
    s_add_u32 m0, s62, 17408
    s_nop 0
    buffer_load_dwordx4 v21, s[44:47], s63 offen lds
    s_add_u32 m0, s62, 18432
    s_nop 0
    buffer_load_dwordx4 v22, s[44:47], s63 offen lds
    s_add_u32 m0, s62, 19456
    s_nop 0
    buffer_load_dwordx4 v23, s[44:47], s63 offen lds
    s_add_u32 s63, s63, 64
    s_barrier
    s_add_u32 m0, s62, 32768
    s_nop 0
    buffer_load_dwordx4 v20, s[44:47], s63 offen lds
    s_add_u32 m0, s62, 33792
    s_nop 0
    buffer_load_dwordx4 v21, s[44:47], s63 offen lds
    s_add_u32 m0, s62, 34816
    s_nop 0
    buffer_load_dwordx4 v22, s[44:47], s63 offen lds
    s_add_u32 m0, s62, 35840
    s_nop 0
    buffer_load_dwordx4 v23, s[44:47], s63 offen lds
    s_add_u32 s63, s63, 64
    s_waitcnt vmcnt(8)
    s_barrier
    s_add_u32 m0, s62, 49152
    s_nop 0
    buffer_load_dwordx4 v20, s[44:47], s63 offen lds
    s_add_u32 m0, s62, 50176
    s_nop 0
    buffer_load_dwordx4 v21, s[44:47], s63 offen lds
    s_add_u32 m0, s62, 51200
    s_nop 0
    buffer_load_dwordx4 v22, s[44:47], s63 offen lds
    s_add_u32 m0, s62, 52224
    s_nop 0
    buffer_load_dwordx4 v23, s[44:47], s63 offen lds
    s_add_u32 s63, s63, 64
    s_waitcnt vmcnt(8)
    s_barrier
    s_add_u32 m0, s62, 0
    s_nop 0
    buffer_load_dwordx4 v20, s[44:47], s63 offen lds
    s_add_u32 m0, s62, 1024
    s_nop 0
    buffer_load_dwordx4 v21, s[44:47], s63 offen lds
    s_add_u32 m0, s62, 2048
    s_nop 0
    buffer_load_dwordx4 v22, s[44:47], s63 offen lds
    s_add_u32 m0, s62, 3072
    s_nop 0
    buffer_load_dwordx4 v23, s[44:47], s63 offen lds
    s_add_u32 s63, s63, 64
    s_waitcnt vmcnt(8)
    s_barrier
    s_add_u32 m0, s62, 16384
    s_nop 0
    buffer_load_dwordx4 v20, s[44:47], s63 offen lds
    s_add_u32 m0, s62, 17408
    s_nop 0
    buffer_load_dwordx4 v21, s[44:47], s63 offen lds
    s_add_u32 m0, s62, 18432
    s_nop 0
    buffer_load_dwordx4 v22, s[44:47], s63 offen lds
    s_add_u32 m0, s62, 19456
    s_nop 0
    buffer_load_dwordx4 v23, s[44:47], s63 offen lds
    s_add_u32 s63, s63, 64
    s_waitcnt vmcnt(8)
    s_barrier
    s_add_u32 m0, s62, 32768
    s_nop 0
    buffer_load_dwordx4 v20, s[44:47], s63 offen lds
    s_add_u32 m0, s62, 33792
    s_nop 0
    buffer_load_dwordx4 v21, s[44:47], s63 offen lds
    s_add_u32 m0, s62, 34816
    s_nop 0
    buffer_load_dwordx4 v22, s[44:47], s63 offen lds
    s_add_u32 m0, s62, 35840
    s_nop 0
    buffer_load_dwordx4 v23, s[44:47], s63 offen lds
    s_add_u32 s63, s63, 64
    s_waitcnt vmcnt(8)
    s_barrier
    s_add_u32 m0, s62, 49152
    s_nop 0
    buffer_load_dwordx4 v20, s[44:47], s63 offen lds
    s_add_u32 m0, s62, 50176
    s_nop 0
    buffer_load_dwordx4 v21, s[44:47], s63 offen lds
    s_add_u32 m0, s62, 51200
    s_nop 0
    buffer_load_dwordx4 v22, s[44:47], s63 offen lds
    s_add_u32 m0, s62, 52224
    s_nop 0
    buffer_load_dwordx4 v23, s[44:47], s63 offen lds
    s_add_u32 s63, s63, 64
    s_waitcnt vmcnt(8)
    s_barrier
    s_add_u32 m0, s62, 0
    s_nop 0
    buffer_load_dwordx4 v20, s[44:47], s63 offen lds
    s_add_u32 m0, s62, 1024
    s_nop 0
    buffer_load_dwordx4 v21, s[44:47], s63 offen lds
    s_add_u32 m0, s62, 2048
    s_nop 0
    buffer_load_dwordx4 v22, s[44:47], s63 offen lds
    s_add_u32 m0, s62, 3072
    s_nop 0
    buffer_load_dwordx4 v23, s[44:47], s63 offen lds
    s_add_u32 s63, s63, 64
    s_waitcnt vmcnt(8)
    s_barrier
    s_add_u32 m0, s62, 16384
    s_nop 0
    buffer_load_dwordx4 v20, s[44:47], s63 offen lds
    s_add_u32 m0, s62, 17408
    s_nop 0
    buffer_load_dwordx4 v21, s[44:47], s63 offen lds
    s_add_u32 m0, s62, 18432
    s_nop 0
    buffer_load_dwordx4 v22, s[44:47], s63 offen lds
    s_add_u32 m0, s62, 19456
    s_nop 0
    buffer_load_dwordx4 v23, s[44:47], s63 offen lds
    s_add_u32 s63, s63, 64
    s_waitcnt vmcnt(8)
    s_barrier
    s_add_u32 m0, s62, 32768
    s_nop 0
    buffer_load_dwordx4 v20, s[44:47], s63 offen lds
    s_add_u32 m0, s62, 33792
    s_nop 0
    buffer_load_dwordx4 v21, s[44:47], s63 offen lds
    s_add_u32 m0, s62, 34816
    s_nop 0
    buffer_load_dwordx4 v22, s[44:47], s63 offen lds
    s_add_u32 m0, s62, 35840
    s_nop 0
    buffer_load_dwordx4 v23, s[44:47], s63 offen lds
    s_add_u32 s63, s63, 64
    s_waitcnt vmcnt(8)
    s_barrier
    s_add_u32 m0, s62, 49152
    s_nop 0
    buffer_load_dwordx4 v20, s[44:47], s63 offen lds
    s_add_u32 m0, s62, 50176
    s_nop 0
    buffer_load_dwordx4 v21, s[44:47], s63 offen lds
    s_add_u32 m0, s62, 51200
    s_nop 0
    buffer_load_dwordx4 v22, s[44:47], s63 offen lds
    s_add_u32 m0, s62, 52224
    s_nop 0
    buffer_load_dwordx4 v23, s[44:47], s63 offen lds
    s_add_u32 s63, s63, 64
    s_waitcnt vmcnt(8)
    s_barrier
    s_waitcnt vmcnt(4)
    s_barrier
    s_waitcnt vmcnt(0)
    s_barrier
    s_branch K1_FIN
S1_CONS:
    s_lshl_b32 s8, s3, 6
    v_add_u32 v8, s8, v4
    v_lshlrev_b32 v8, 6, v8
    v_add_u32 v8, 69632, v8
    v_lshrrev_b32 v9, 2, v4
    v_and_b32 v9, 3, v9
    v_xor_b32 v9, v9, v5
    v_lshl_add_u32 v6, v9, 4, v8
    v_xor_b32 v9, 2, v9
    v_lshl_add_u32 v7, v9, 4, v8
    v_lshlrev_b32 v12, 9, v5
    v_lshlrev_b32 v20, 4, v5
    v_add_u32 v20, 65536, v20
    v_add_u32 v13, 0, v5
    v_xor_b32 v13, v13, v4
    v_lshl_add_u32 v16, v13, 4, v12
    v_add_u32 v13, 2, v5
    v_xor_b32 v13, v13, v4
    v_lshl_add_u32 v17, v13, 4, v12
    v_add_u32 v13, 4, v5
    v_xor_b32 v13, v13, v4
    v_lshl_add_u32 v18, v13, 4, v12
    v_add_u32 v13, 6, v5
    v_xor_b32 v13, v13, v4
    v_lshl_add_u32 v19, v13, 4, v12
    s_waitcnt lgkmcnt(0)
    s_barrier
    ds_read_b128 v[64:67], v16 offset:0
    ds_read_b128 v[76:79], v6 offset:0
    ds_read_b128 v[68:71], v16 offset:32768
    ds_read_b128 v[80:83], v6 offset:2048
    ds_read_b128 v[72:75], v20 offset:0
    s_waitcnt lgkmcnt(0)
    v_mfma_f32_32x32x16_bf16 v[128:143], v[64:67], v[76:79], 0
    ds_read_b128 v[88:91], v17 offset:1024
    v_mfma_f32_32x32x16_bf16 v[144:159], v[64:67], v[80:83], 0
    ds_read_b128 v[100:103], v7 offset:0
    v_mfma_f32_32x32x16_bf16 v[160:175], v[68:71], v[76:79], 0
    ds_read_b128 v[92:95], v17 offset:33792
    v_mfma_f32_32x32x16_bf16 v[176:191], v[68:71], v[80:83], 0
    ds_read_b128 v[104:107], v7 offset:2048
    v_mfma_f32_32x32x16_bf16 v[192:207], v[72:75], v[76:79], 0
    ds_read_b128 v[96:99], v20 offset:32
    v_mfma_f32_32x32x16_bf16 v[208:223], v[72:75], v[80:83], 0
    s_waitcnt lgkmcnt(0)
    s_barrier
    v_mfma_f32_32x32x16_bf16 v[128:143], v[88:91], v[100:103], v[128:143]
    ds_read_b128 v[64:67], v18 offset:2048
    v_mfma_f32_32x32x16_bf16 v[144:159], v[88:91], v[104:107], v[144:159]
    ds_read_b128 v[76:79], v6 offset:16384
    v_mfma_f32_32x32x16_bf16 v[160:175], v[92:95], v[100:103], v[160:175]
    ds_read_b128 v[68:71], v18 offset:34816
    v_mfma_f32_32x32x16_bf16 v[176:191], v[92:95], v[104:107], v[176:191]
    ds_read_b128 v[80:83], v6 offset:18432
    v_mfma_f32_32x32x16_bf16 v[192:207], v[96:99], v[100:103], v[192:207]
    ds_read_b128 v[72:75], v20 offset:64
    v_mfma_f32_32x32x16_bf16 v[208:223], v[96:99], v[104:107], v[208:223]
    s_waitcnt lgkmcnt(0)
    v_mfma_f32_32x32x16_bf16 v[128:143], v[64:67], v[76:79], v[128:143]
    ds_read_b128 v[88:91], v19 offset:3072
    v_mfma_f32_32x32x16_bf16 v[144:159], v[64:67], v[80:83], v[144:159]
    ds_read_b128 v[100:103], v7 offset:16384
    v_mfma_f32_32x32x16_bf16 v[160:175], v[68:71], v[76:79], v[160:175]
    ds_read_b128 v[92:95], v19 offset:35840
    v_mfma_f32_32x32x16_bf16 v[176:191], v[68:71], v[80:83], v[176:191]
    ds_read_b128 v[104:107], v7 offset:18432
    v_mfma_f32_32x32x16_bf16 v[192:207], v[72:75], v[76:79], v[192:207]
    ds_read_b128 v[96:99], v20 offset:96
    v_mfma_f32_32x32x16_bf16 v[208:223], v[72:75], v[80:83], v[208:223]
    s_waitcnt lgkmcnt(0)
    s_barrier
    v_mfma_f32_32x32x16_bf16 v[128:143], v[88:91], v[100:103], v[128:143]
    ds_read_b128 v[64:67], v16 offset:4096
    v_mfma_f32_32x32x16_bf16 v[144:159], v[88:91], v[104:107], v[144:159]
    ds_read_b128 v[76:79], v6 offset:32768
    v_mfma_f32_32x32x16_bf16 v[160:175], v[92:95], v[100:103], v[160:175]
    ds_read_b128 v[68:71], v16 offset:36864
    v_mfma_f32_32x32x16_bf16 v[176:191], v[92:95], v[104:107], v[176:191]
    ds_read_b128 v[80:83], v6 offset:34816
    v_mfma_f32_32x32x16_bf16 v[192:207], v[96:99], v[100:103], v[192:207]
    ds_read_b128 v[72:75], v20 offset:128
    v_mfma_f32_32x32x16_bf16 v[208:223], v[96:99], v[104:107], v[208:223]
    s_waitcnt lgkmcnt(0)
    v_mfma_f32_32x32x16_bf16 v[128:143], v[64:67], v[76:79], v[128:143]
    ds_read_b128 v[88:91], v17 offset:5120
    v_mfma_f32_32x32x16_bf16 v[144:159], v[64:67], v[80:83], v[144:159]
    ds_read_b128 v[100:103], v7 offset:32768
    v_mfma_f32_32x32x16_bf16 v[160:175], v[68:71], v[76:79], v[160:175]
    ds_read_b128 v[92:95], v17 offset:37888
    v_mfma_f32_32x32x16_bf16 v[176:191], v[68:71], v[80:83], v[176:191]
    ds_read_b128 v[104:107], v7 offset:34816
    v_mfma_f32_32x32x16_bf16 v[192:207], v[72:75], v[76:79], v[192:207]
    ds_read_b128 v[96:99], v20 offset:160
    v_mfma_f32_32x32x16_bf16 v[208:223], v[72:75], v[80:83], v[208:223]
    s_waitcnt lgkmcnt(0)
    s_barrier
    v_mfma_f32_32x32x16_bf16 v[128:143], v[88:91], v[100:103], v[128:143]
    ds_read_b128 v[64:67], v18 offset:6144
    v_mfma_f32_32x32x16_bf16 v[144:159], v[88:91], v[104:107], v[144:159]
    ds_read_b128 v[76:79], v6 offset:49152
    v_mfma_f32_32x32x16_bf16 v[160:175], v[92:95], v[100:103], v[160:175]
    ds_read_b128 v[68:71], v18 offset:38912
    v_mfma_f32_32x32x16_bf16 v[176:191], v[92:95], v[104:107], v[176:191]
    ds_read_b128 v[80:83], v6 offset:51200
    v_mfma_f32_32x32x16_bf16 v[192:207], v[96:99], v[100:103], v[192:207]
    ds_read_b128 v[72:75], v20 offset:192
    v_mfma_f32_32x32x16_bf16 v[208:223], v[96:99], v[104:107], v[208:223]
    s_waitcnt lgkmcnt(0)
    v_mfma_f32_32x32x16_bf16 v[128:143], v[64:67], v[76:79], v[128:143]
    ds_read_b128 v[88:91], v19 offset:7168
    v_mfma_f32_32x32x16_bf16 v[144:159], v[64:67], v[80:83], v[144:159]
    ds_read_b128 v[100:103], v7 offset:49152
    v_mfma_f32_32x32x16_bf16 v[160:175], v[68:71], v[76:79], v[160:175]
    ds_read_b128 v[92:95], v19 offset:39936
    v_mfma_f32_32x32x16_bf16 v[176:191], v[68:71], v[80:83], v[176:191]
    ds_read_b128 v[104:107], v7 offset:51200
    v_mfma_f32_32x32x16_bf16 v[192:207], v[72:75], v[76:79], v[192:207]
    ds_read_b128 v[96:99], v20 offset:224
    v_mfma_f32_32x32x16_bf16 v[208:223], v[72:75], v[80:83], v[208:223]
    s_waitcnt lgkmcnt(0)
    s_barrier
    v_mfma_f32_32x32x16_bf16 v[128:143], v[88:91], v[100:103], v[128:143]
    ds_read_b128 v[64:67], v16 offset:8192
    v_mfma_f32_32x32x16_bf16 v[144:159], v[88:91], v[104:107], v[144:159]
    ds_read_b128 v[76:79], v6 offset:0
    v_mfma_f32_32x32x16_bf16 v[160:175], v[92:95], v[100:103], v[160:175]
    ds_read_b128 v[68:71], v16 offset:40960
    v_mfma_f32_32x32x16_bf16 v[176:191], v[92:95], v[104:107], v[176:191]
    ds_read_b128 v[80:83], v6 offset:2048
    v_mfma_f32_32x32x16_bf16 v[192:207], v[96:99], v[100:103], v[192:207]
    ds_read_b128 v[72:75], v20 offset:256
    v_mfma_f32_32x32x16_bf16 v[208:223], v[96:99], v[104:107], v[208:223]
    s_waitcnt lgkmcnt(0)
    v_mfma_f32_32x32x16_bf16 v[128:143], v[64:67], v[76:79], v[128:143]
    ds_read_b128 v[88:91], v17 offset:9216
    v_mfma_f32_32x32x16_bf16 v[144:159], v[64:67], v[80:83], v[144:159]
    ds_read_b128 v[100:103], v7 offset:0
    v_mfma_f32_32x32x16_bf16 v[160:175], v[68:71], v[76:79], v[160:175]
    ds_read_b128 v[92:95], v17 offset:41984
    v_mfma_f32_32x32x16_bf16 v[176:191], v[68:71], v[80:83], v[176:191]
    ds_read_b128 v[104:107], v7 offset:2048
    v_mfma_f32_32x32x16_bf16 v[192:207], v[72:75], v[76:79], v[192:207]
    ds_read_b128 v[96:99], v20 offset:288
    v_mfma_f32_32x32x16_bf16 v[208:223], v[72:75], v[80:83], v[208:223]
    s_waitcnt lgkmcnt(0)
    s_barrier
    v_mfma_f32_32x32x16_bf16 v[128:143], v[88:91], v[100:103], v[128:143]
    ds_read_b128 v[64:67], v18 offset:10240
    v_mfma_f32_32x32x16_bf16 v[144:159], v[88:91], v[104:107], v[144:159]
    ds_read_b128 v[76:79], v6 offset:16384
    v_mfma_f32_32x32x16_bf16 v[160:175], v[92:95], v[100:103], v[160:175]
    ds_read_b128 v[68:71], v18 offset:43008
    v_mfma_f32_32x32x16_bf16 v[176:191], v[92:95], v[104:107], v[176:191]
    ds_read_b128 v[80:83], v6 offset:18432
    v_mfma_f32_32x32x16_bf16 v[192:207], v[96:99], v[100:103], v[192:207]
    ds_read_b128 v[72:75], v20 offset:320
    v_mfma_f32_32x32x16_bf16 v[208:223], v[96:99], v[104:107], v[208:223]
    s_waitcnt lgkmcnt(0)
    v_mfma_f32_32x32x16_bf16 v[128:143], v[64:67], v[76:79], v[128:143]
    ds_read_b128 v[88:91], v19 offset:11264
    v_mfma_f32_32x32x16_bf16 v[144:159], v[64:67], v[80:83], v[144:159]
    ds_read_b128 v[100:103], v7 offset:16384
    v_mfma_f32_32x32x16_bf16 v[160:175], v[68:71], v[76:79], v[160:175]
    ds_read_b128 v[92:95], v19 offset:44032
    v_mfma_f32_32x32x16_bf16 v[176:191], v[68:71], v[80:83], v[176:191]
    ds_read_b128 v[104:107], v7 offset:18432
    v_mfma_f32_32x32x16_bf16 v[192:207], v[72:75], v[76:79], v[192:207]
    ds_read_b128 v[96:99], v20 offset:352
    v_mfma_f32_32x32x16_bf16 v[208:223], v[72:75], v[80:83], v[208:223]
    s_waitcnt lgkmcnt(0)
    s_barrier
    v_mfma_f32_32x32x16_bf16 v[128:143], v[88:91], v[100:103], v[128:143]
    ds_read_b128 v[64:67], v16 offset:12288
    v_mfma_f32_32x32x16_bf16 v[144:159], v[88:91], v[104:107], v[144:159]
    ds_read_b128 v[76:79], v6 offset:32768
    v_mfma_f32_32x32x16_bf16 v[160:175], v[92:95], v[100:103], v[160:175]
    ds_read_b128 v[68:71], v16 offset:45056
    v_mfma_f32_32x32x16_bf16 v[176:191], v[92:95], v[104:107], v[176:191]
    ds_read_b128 v[80:83], v6 offset:34816
    v_mfma_f32_32x32x16_bf16 v[192:207], v[96:99], v[100:103], v[192:207]
    ds_read_b128 v[72:75], v20 offset:384
    v_mfma_f32_32x32x16_bf16 v[208:223], v[96:99], v[104:107], v[208:223]
    s_waitcnt lgkmcnt(0)
    v_mfma_f32_32x32x16_bf16 v[128:143], v[64:67], v[76:79], v[128:143]
    ds_read_b128 v[88:91], v17 offset:13312
    v_mfma_f32_32x32x16_bf16 v[144:159], v[64:67], v[80:83], v[144:159]
    ds_read_b128 v[100:103], v7 offset:32768
    v_mfma_f32_32x32x16_bf16 v[160:175], v[68:71], v[76:79], v[160:175]
    ds_read_b128 v[92:95], v17 offset:46080
    v_mfma_f32_32x32x16_bf16 v[176:191], v[68:71], v[80:83], v[176:191]
    ds_read_b128 v[104:107], v7 offset:34816
    v_mfma_f32_32x32x16_bf16 v[192:207], v[72:75], v[76:79], v[192:207]
    ds_read_b128 v[96:99], v20 offset:416
    v_mfma_f32_32x32x16_bf16 v[208:223], v[72:75], v[80:83], v[208:223]
    s_waitcnt lgkmcnt(0)
    s_barrier
    v_mfma_f32_32x32x16_bf16 v[128:143], v[88:91], v[100:103], v[128:143]
    ds_read_b128 v[64:67], v18 offset:14336
    v_mfma_f32_32x32x16_bf16 v[144:159], v[88:91], v[104:107], v[144:159]
    ds_read_b128 v[76:79], v6 offset:49152
    v_mfma_f32_32x32x16_bf16 v[160:175], v[92:95], v[100:103], v[160:175]
    ds_read_b128 v[68:71], v18 offset:47104
    v_mfma_f32_32x32x16_bf16 v[176:191], v[92:95], v[104:107], v[176:191]
    ds_read_b128 v[80:83], v6 offset:51200
    v_mfma_f32_32x32x16_bf16 v[192:207], v[96:99], v[100:103], v[192:207]
    ds_read_b128 v[72:75], v20 offset:448
    v_mfma_f32_32x32x16_bf16 v[208:223], v[96:99], v[104:107], v[208:223]
    s_waitcnt lgkmcnt(0)
    v_mfma_f32_32x32x16_bf16 v[128:143], v[64:67], v[76:79], v[128:143]
    ds_read_b128 v[88:91], v19 offset:15360
    v_mfma_f32_32x32x16_bf16 v[144:159], v[64:67], v[80:83], v[144:159]
    ds_read_b128 v[100:103], v7 offset:49152
    v_mfma_f32_32x32x16_bf16 v[160:175], v[68:71], v[76:79], v[160:175]
    ds_read_b128 v[92:95], v19 offset:48128
    v_mfma_f32_32x32x16_bf16 v[176:191], v[68:71], v[80:83], v[176:191]
    ds_read_b128 v[104:107], v7 offset:51200
    v_mfma_f32_32x32x16_bf16 v[192:207], v[72:75], v[76:79], v[192:207]
    ds_read_b128 v[96:99], v20 offset:480
    v_mfma_f32_32x32x16_bf16 v[208:223], v[72:75], v[80:83], v[208:223]
    s_waitcnt lgkmcnt(0)
    s_barrier
    v_mfma_f32_32x32x16_bf16 v[128:143], v[88:91], v[100:103], v[128:143]
    ds_read_b128 v[64:67], v16 offset:16384
    v_mfma_f32_32x32x16_bf16 v[144:159], v[88:91], v[104:107], v[144:159]
    ds_read_b128 v[76:79], v6 offset:0
    v_mfma_f32_32x32x16_bf16 v[160:175], v[92:95], v[100:103], v[160:175]
    ds_read_b128 v[68:71], v16 offset:49152
    v_mfma_f32_32x32x16_bf16 v[176:191], v[92:95], v[104:107], v[176:191]
    ds_read_b128 v[80:83], v6 offset:2048
    v_mfma_f32_32x32x16_bf16 v[192:207], v[96:99], v[100:103], v[192:207]
    ds_read_b128 v[72:75], v20 offset:512
    v_mfma_f32_32x32x16_bf16 v[208:223], v[96:99], v[104:107], v[208:223]
    s_waitcnt lgkmcnt(0)
    v_mfma_f32_32x32x16_bf16 v[128:143], v[64:67], v[76:79], v[128:143]
    ds_read_b128 v[88:91], v17 offset:17408
    v_mfma_f32_32x32x16_bf16 v[144:159], v[64:67], v[80:83], v[144:159]
    ds_read_b128 v[100:103], v7 offset:0
    v_mfma_f32_32x32x16_bf16 v[160:175], v[68:71], v[76:79], v[160:175]
    ds_read_b128 v[92:95], v17 offset:50176
    v_mfma_f32_32x32x16_bf16 v[176:191], v[68:71], v[80:83], v[176:191]
    ds_read_b128 v[104:107], v7 offset:2048
    v_mfma_f32_32x32x16_bf16 v[192:207], v[72:75], v[76:79], v[192:207]
    ds_read_b128 v[96:99], v20 offset:544
    v_mfma_f32_32x32x16_bf16 v[208:223], v[72:75], v[80:83], v[208:223]
    s_waitcnt lgkmcnt(0)
    s_barrier
    v_mfma_f32_32x32x16_bf16 v[128:143], v[88:91], v[100:103], v[128:143]
    ds_read_b128 v[64:67], v18 offset:18432
    v_mfma_f32_32x32x16_bf16 v[144:159], v[88:91], v[104:107], v[144:159]
    ds_read_b128 v[76:79], v6 offset:16384
    v_mfma_f32_32x32x16_bf16 v[160:175], v[92:95], v[100:103], v[160:175]
    ds_read_b128 v[68:71], v18 offset:51200
    v_mfma_f32_32x32x16_bf16 v[176:191], v[92:95], v[104:107], v[176:191]
    ds_read_b128 v[80:83], v6 offset:18432
    v_mfma_f32_32x32x16_bf16 v[192:207], v[96:99], v[100:103], v[192:207]
    ds_read_b128 v[72:75], v20 offset:576
    v_mfma_f32_32x32x16_bf16 v[208:223], v[96:99], v[104:107], v[208:223]
    s_waitcnt lgkmcnt(0)
    v_mfma_f32_32x32x16_bf16 v[128:143], v[64:67], v[76:79], v[128:143]
    ds_read_b128 v[88:91], v19 offset:19456
    v_mfma_f32_32x32x16_bf16 v[144:159], v[64:67], v[80:83], v[144:159]
    ds_read_b128 v[100:103], v7 offset:16384
    v_mfma_f32_32x32x16_bf16 v[160:175], v[68:71], v[76:79], v[160:175]
    ds_read_b128 v[92:95], v19 offset:52224
    v_mfma_f32_32x32x16_bf16 v[176:191], v[68:71], v[80:83], v[176:191]
    ds_read_b128 v[104:107], v7 offset:18432
    v_mfma_f32_32x32x16_bf16 v[192:207], v[72:75], v[76:79], v[192:207]
    ds_read_b128 v[96:99], v20 offset:608
    v_mfma_f32_32x32x16_bf16 v[208:223], v[72:75], v[80:83], v[208:223]
    s_waitcnt lgkmcnt(0)
    s_barrier
    v_mfma_f32_32x32x16_bf16 v[128:143], v[88:91], v[100:103], v[128:143]
    ds_read_b128 v[64:67], v16 offset:20480
    v_mfma_f32_32x32x16_bf16 v[144:159], v[88:91], v[104:107], v[144:159]
    ds_read_b128 v[76:79], v6 offset:32768
    v_mfma_f32_32x32x16_bf16 v[160:175], v[92:95], v[100:103], v[160:175]
    ds_read_b128 v[68:71], v16 offset:53248
    v_mfma_f32_32x32x16_bf16 v[176:191], v[92:95], v[104:107], v[176:191]
    ds_read_b128 v[80:83], v6 offset:34816
    v_mfma_f32_32x32x16_bf16 v[192:207], v[96:99], v[100:103], v[192:207]
    ds_read_b128 v[72:75], v20 offset:640
    v_mfma_f32_32x32x16_bf16 v[208:223], v[96:99], v[104:107], v[208:223]
    s_waitcnt lgkmcnt(0)
    v_mfma_f32_32x32x16_bf16 v[128:143], v[64:67], v[76:79], v[128:143]
    ds_read_b128 v[88:91], v17 offset:21504
    v_mfma_f32_32x32x16_bf16 v[144:159], v[64:67], v[80:83], v[144:159]
    ds_read_b128 v[100:103], v7 offset:32768
    v_mfma_f32_32x32x16_bf16 v[160:175], v[68:71], v[76:79], v[160:175]
    ds_read_b128 v[92:95], v17 offset:54272
    v_mfma_f32_32x32x16_bf16 v[176:191], v[68:71], v[80:83], v[176:191]
    ds_read_b128 v[104:107], v7 offset:34816
    v_mfma_f32_32x32x16_bf16 v[192:207], v[72:75], v[76:79], v[192:207]
    ds_read_b128 v[96:99], v20 offset:672
    v_mfma_f32_32x32x16_bf16 v[208:223], v[72:75], v[80:83], v[208:223]
    s_waitcnt lgkmcnt(0)
    s_barrier
    v_mfma_f32_32x32x16_bf16 v[128:143], v[88:91], v[100:103], v[128:143]
    ds_read_b128 v[64:67], v18 offset:22528
    v_mfma_f32_32x32x16_bf16 v[144:159], v[88:91], v[104:107], v[144:159]
    ds_read_b128 v[76:79], v6 offset:49152
    v_mfma_f32_32x32x16_bf16 v[160:175], v[92:95], v[100:103], v[160:175]
    ds_read_b128 v[68:71], v18 offset:55296
    v_mfma_f32_32x32x16_bf16 v[176:191], v[92:95], v[104:107], v[176:191]
    ds_read_b128 v[80:83], v6 offset:51200
    v_mfma_f32_32x32x16_bf16 v[192:207], v[96:99], v[100:103], v[192:207]
    ds_read_b128 v[72:75], v20 offset:704
    v_mfma_f32_32x32x16_bf16 v[208:223], v[96:99], v[104:107], v[208:223]
    s_waitcnt lgkmcnt(0)
    v_mfma_f32_32x32x16_bf16 v[128:143], v[64:67], v[76:79], v[128:143]
    ds_read_b128 v[88:91], v19 offset:23552
    v_mfma_f32_32x32x16_bf16 v[144:159], v[64:67], v[80:83], v[144:159]
    ds_read_b128 v[100:103], v7 offset:49152
    v_mfma_f32_32x32x16_bf16 v[160:175], v[68:71], v[76:79], v[160:175]
    ds_read_b128 v[92:95], v19 offset:56320
    v_mfma_f32_32x32x16_bf16 v[176:191], v[68:71], v[80:83], v[176:191]
    ds_read_b128 v[104:107], v7 offset:51200
    v_mfma_f32_32x32x16_bf16 v[192:207], v[72:75], v[76:79], v[192:207]
    ds_read_b128 v[96:99], v20 offset:736
    v_mfma_f32_32x32x16_bf16 v[208:223], v[72:75], v[80:83], v[208:223]
    s_waitcnt lgkmcnt(0)
    s_barrier
    v_mfma_f32_32x32x16_bf16 v[128:143], v[88:91], v[100:103], v[128:143]
    ds_read_b128 v[64:67], v16 offset:24576
    v_mfma_f32_32x32x16_bf16 v[144:159], v[88:91], v[104:107], v[144:159]
    ds_read_b128 v[76:79], v6 offset:0
    v_mfma_f32_32x32x16_bf16 v[160:175], v[92:95], v[100:103], v[160:175]
    ds_read_b128 v[68:71], v16 offset:57344
    v_mfma_f32_32x32x16_bf16 v[176:191], v[92:95], v[104:107], v[176:191]
    ds_read_b128 v[80:83], v6 offset:2048
    v_mfma_f32_32x32x16_bf16 v[192:207], v[96:99], v[100:103], v[192:207]
    ds_read_b128 v[72:75], v20 offset:768
    v_mfma_f32_32x32x16_bf16 v[208:223], v[96:99], v[104:107], v[208:223]
    s_waitcnt lgkmcnt(0)
    v_mfma_f32_32x32x16_bf16 v[128:143], v[64:67], v[76:79], v[128:143]
    ds_read_b128 v[88:91], v17 offset:25600
    v_mfma_f32_32x32x16_bf16 v[144:159], v[64:67], v[80:83], v[144:159]
    ds_read_b128 v[100:103], v7 offset:0
    v_mfma_f32_32x32x16_bf16 v[160:175], v[68:71], v[76:79], v[160:175]
    ds_read_b128 v[92:95], v17 offset:58368
    v_mfma_f32_32x32x16_bf16 v[176:191], v[68:71], v[80:83], v[176:191]
    ds_read_b128 v[104:107], v7 offset:2048
    v_mfma_f32_32x32x16_bf16 v[192:207], v[72:75], v[76:79], v[192:207]
    ds_read_b128 v[96:99], v20 offset:800
    v_mfma_f32_32x32x16_bf16 v[208:223], v[72:75], v[80:83], v[208:223]
    s_waitcnt lgkmcnt(0)
    s_barrier
    v_mfma_f32_32x32x16_bf16 v[128:143], v[88:91], v[100:103], v[128:143]
    ds_read_b128 v[64:67], v18 offset:26624
    v_mfma_f32_32x32x16_bf16 v[144:159], v[88:91], v[104:107], v[144:159]
    ds_read_b128 v[76:79], v6 offset:16384
    v_mfma_f32_32x32x16_bf16 v[160:175], v[92:95], v[100:103], v[160:175]
    ds_read_b128 v[68:71], v18 offset:59392
    v_mfma_f32_32x32x16_bf16 v[176:191], v[92:95], v[104:107], v[176:191]
    ds_read_b128 v[80:83], v6 offset:18432
    v_mfma_f32_32x32x16_bf16 v[192:207], v[96:99], v[100:103], v[192:207]
    ds_read_b128 v[72:75], v20 offset:832
    v_mfma_f32_32x32x16_bf16 v[208:223], v[96:99], v[104:107], v[208:223]
    s_waitcnt lgkmcnt(0)
    v_mfma_f32_32x32x16_bf16 v[128:143], v[64:67], v[76:79], v[128:143]
    ds_read_b128 v[88:91], v19 offset:27648
    v_mfma_f32_32x32x16_bf16 v[144:159], v[64:67], v[80:83], v[144:159]
    ds_read_b128 v[100:103], v7 offset:16384
    v_mfma_f32_32x32x16_bf16 v[160:175], v[68:71], v[76:79], v[160:175]
    ds_read_b128 v[92:95], v19 offset:60416
    v_mfma_f32_32x32x16_bf16 v[176:191], v[68:71], v[80:83], v[176:191]
    ds_read_b128 v[104:107], v7 offset:18432
    v_mfma_f32_32x32x16_bf16 v[192:207], v[72:75], v[76:79], v[192:207]
    ds_read_b128 v[96:99], v20 offset:864
    v_mfma_f32_32x32x16_bf16 v[208:223], v[72:75], v[80:83], v[208:223]
    s_waitcnt lgkmcnt(0)
    s_barrier
    v_mfma_f32_32x32x16_bf16 v[128:143], v[88:91], v[100:103], v[128:143]
    ds_read_b128 v[64:67], v16 offset:28672
    v_mfma_f32_32x32x16_bf16 v[144:159], v[88:91], v[104:107], v[144:159]
    ds_read_b128 v[76:79], v6 offset:32768
    v_mfma_f32_32x32x16_bf16 v[160:175], v[92:95], v[100:103], v[160:175]
    ds_read_b128 v[68:71], v16 offset:61440
    v_mfma_f32_32x32x16_bf16 v[176:191], v[92:95], v[104:107], v[176:191]
    ds_read_b128 v[80:83], v6 offset:34816
    v_mfma_f32_32x32x16_bf16 v[192:207], v[96:99], v[100:103], v[192:207]
    ds_read_b128 v[72:75], v20 offset:896
    v_mfma_f32_32x32x16_bf16 v[208:223], v[96:99], v[104:107], v[208:223]
    s_waitcnt lgkmcnt(0)
    v_mfma_f32_32x32x16_bf16 v[128:143], v[64:67], v[76:79], v[128:143]
    ds_read_b128 v[88:91], v17 offset:29696
    v_mfma_f32_32x32x16_bf16 v[144:159], v[64:67], v[80:83], v[144:159]
    ds_read_b128 v[100:103], v7 offset:32768
    v_mfma_f32_32x32x16_bf16 v[160:175], v[68:71], v[76:79], v[160:175]
    ds_read_b128 v[92:95], v17 offset:62464
    v_mfma_f32_32x32x16_bf16 v[176:191], v[68:71], v[80:83], v[176:191]
    ds_read_b128 v[104:107], v7 offset:34816
    v_mfma_f32_32x32x16_bf16 v[192:207], v[72:75], v[76:79], v[192:207]
    ds_read_b128 v[96:99], v20 offset:928
    v_mfma_f32_32x32x16_bf16 v[208:223], v[72:75], v[80:83], v[208:223]
    s_waitcnt lgkmcnt(0)
    s_barrier
    v_mfma_f32_32x32x16_bf16 v[128:143], v[88:91], v[100:103], v[128:143]
    ds_read_b128 v[64:67], v18 offset:30720
    v_mfma_f32_32x32x16_bf16 v[144:159], v[88:91], v[104:107], v[144:159]
    ds_read_b128 v[76:79], v6 offset:49152
    v_mfma_f32_32x32x16_bf16 v[160:175], v[92:95], v[100:103], v[160:175]
    ds_read_b128 v[68:71], v18 offset:63488
    v_mfma_f32_32x32x16_bf16 v[176:191], v[92:95], v[104:107], v[176:191]
    ds_read_b128 v[80:83], v6 offset:51200
    v_mfma_f32_32x32x16_bf16 v[192:207], v[96:99], v[100:103], v[192:207]
    ds_read_b128 v[72:75], v20 offset:960
    v_mfma_f32_32x32x16_bf16 v[208:223], v[96:99], v[104:107], v[208:223]
    s_waitcnt lgkmcnt(0)
    v_mfma_f32_32x32x16_bf16 v[128:143], v[64:67], v[76:79], v[128:143]
    ds_read_b128 v[88:91], v19 offset:31744
    v_mfma_f32_32x32x16_bf16 v[144:159], v[64:67], v[80:83], v[144:159]
    ds_read_b128 v[100:103], v7 offset:49152
    v_mfma_f32_32x32x16_bf16 v[160:175], v[68:71], v[76:79], v[160:175]
    ds_read_b128 v[92:95], v19 offset:64512
    v_mfma_f32_32x32x16_bf16 v[176:191], v[68:71], v[80:83], v[176:191]
    ds_read_b128 v[104:107], v7 offset:51200
    v_mfma_f32_32x32x16_bf16 v[192:207], v[72:75], v[76:79], v[192:207]
    ds_read_b128 v[96:99], v20 offset:992
    v_mfma_f32_32x32x16_bf16 v[208:223], v[72:75], v[80:83], v[208:223]
    s_waitcnt lgkmcnt(0)
    v_mfma_f32_32x32x16_bf16 v[128:143], v[88:91], v[100:103], v[128:143]
    v_mfma_f32_32x32x16_bf16 v[144:159], v[88:91], v[104:107], v[144:159]
    v_mfma_f32_32x32x16_bf16 v[160:175], v[92:95], v[100:103], v[160:175]
    v_mfma_f32_32x32x16_bf16 v[176:191], v[92:95], v[104:107], v[176:191]
    v_mfma_f32_32x32x16_bf16 v[192:207], v[96:99], v[100:103], v[192:207]
    v_mfma_f32_32x32x16_bf16 v[208:223], v[96:99], v[104:107], v[208:223]
    s_nop 7
    s_nop 7
    s_lshl_b32 s8, s5, 1
    s_add_u32 s9, s8, s5
    s_sub_u32 s10, 1, s5
    s_add_u32 s10, s10, s8
    s_lshl_b32 s11, s3, 1
    s_lshl_b32 s9, s9, 3
    s_add_u32 s9, s9, s11
    s_lshl_b32 s9, s9, 5
    s_lshl_b32 s10, s10, 3
    s_add_u32 s10, s10, s11
    s_lshl_b32 s10, s10, 5
    s_lshl_b32 s11, s6, 1
    s_add_u32 s9, s9, s11
    s_add_u32 s10, s10, s11
    s_lshl_b32 s9, s9, 10
    s_lshl_b32 s10, s10, 10
    s_add_u32 s9, s9, 11272192
    s_add_u32 s10, s10, 11272192
    s_add_u32 s12, s9, 32768
    s_add_u32 s13, s10, 32768
    v_lshlrev_b32 v8, 4, v1
    v_cvt_pk_bf16_f32 v64, v128, v129
    v_cvt_pk_bf16_f32 v65, v130, v131
    v_cvt_pk_bf16_f32 v66, v132, v133
    v_cvt_pk_bf16_f32 v67, v134, v135
    v_cvt_pk_bf16_f32 v68, v136, v137
    v_cvt_pk_bf16_f32 v69, v138, v139
    v_cvt_pk_bf16_f32 v70, v140, v141
    v_cvt_pk_bf16_f32 v71, v142, v143
    buffer_store_dwordx4 v[64:67], v8, s[40:43], s9 offen offset:0
    buffer_store_dwordx4 v[68:71], v8, s[40:43], s9 offen offset:1024
    v_cvt_pk_bf16_f32 v72, v144, v145
    v_cvt_pk_bf16_f32 v73, v146, v147
    v_cvt_pk_bf16_f32 v74, v148, v149
    v_cvt_pk_bf16_f32 v75, v150, v151
    v_cvt_pk_bf16_f32 v76, v152, v153
    v_cvt_pk_bf16_f32 v77, v154, v155
    v_cvt_pk_bf16_f32 v78, v156, v157
    v_cvt_pk_bf16_f32 v79, v158, v159
    buffer_store_dwordx4 v[72:75], v8, s[40:43], s12 offen offset:0
    buffer_store_dwordx4 v[76:79], v8, s[40:43], s12 offen offset:1024
    v_cvt_pk_bf16_f32 v80, v160, v161
    v_cvt_pk_bf16_f32 v81, v162, v163
    v_cvt_pk_bf16_f32 v82, v164, v165
    v_cvt_pk_bf16_f32 v83, v166, v167
    v_cvt_pk_bf16_f32 v84, v168, v169
    v_cvt_pk_bf16_f32 v85, v170, v171
    v_cvt_pk_bf16_f32 v86, v172, v173
    v_cvt_pk_bf16_f32 v87, v174, v175
    buffer_store_dwordx4 v[80:83], v8, s[40:43], s10 offen offset:0
    buffer_store_dwordx4 v[84:87], v8, s[40:43], s10 offen offset:1024
    v_cvt_pk_bf16_f32 v88, v176, v177
    v_cvt_pk_bf16_f32 v89, v178, v179
    v_cvt_pk_bf16_f32 v90, v180, v181
    v_cvt_pk_bf16_f32 v91, v182, v183
    v_cvt_pk_bf16_f32 v92, v184, v185
    v_cvt_pk_bf16_f32 v93, v186, v187
    v_cvt_pk_bf16_f32 v94, v188, v189
    v_cvt_pk_bf16_f32 v95, v190, v191
    buffer_store_dwordx4 v[88:91], v8, s[40:43], s13 offen offset:0
    buffer_store_dwordx4 v[92:95], v8, s[40:43], s13 offen offset:1024
    s_cmp_eq_u32 s4, 0
    s_cbranch_scc0 K1_FIN
    s_lshl_b32 s8, s3, 8
    s_add_u32 s8, s8, 12320768
    v_lshlrev_b32 v8, 2, v4
    s_mov_b64 s[68:69], exec
    s_mov_b32 exec_lo, -1
    s_mov_b32 exec_hi, 0
    buffer_store_dword v192, v8, s[40:43], s8 offen
    buffer_store_dword v208, v8, s[40:43], s8 offen offset:128
    s_mov_b64 exec, s[68:69]
K1_FIN:
K1_END:
    s_endpgm
    .p2align 8
    .globl fnet_glu_combine_kernel
    .type fnet_glu_combine_kernel,@function
fnet_glu_combine_kernel:
    s_cmp_ge_u32 s2, 256
    s_cbranch_scc1 K2_END
    s_load_dwordx2 s[16:17], s[0:1], 0
    s_load_dwordx2 s[18:19], s[0:1], 72
    s_load_dwordx2 s[20:21], s[0:1], 88
    v_and_b32 v1, 63, v0
    v_lshrrev_b32 v2, 6, v0
    s_nop 0
    v_readfirstlane_b32 s3, v2
    s_and_b32 s4, s2, 7
    s_lshr_b32 s5, s2, 3
    s_and_b32 s6, s4, 1
    s_lshr_b32 s7, s4, 1
    s_lshl_b32 s7, s7, 2
    s_and_b32 s8, s5, 3
    s_add_u32 s7, s7, s8
    s_lshr_b32 s8, s5, 2
    s_lshl_b32 s9, s6, 4
    s_add_u32 s9, s9, s7
    s_lshr_b32 s10, s3, 1
    s_and_b32 s11, s3, 1
    s_waitcnt lgkmcnt(0)
    s_mov_b32 s32, s20
    s_and_b32 s33, s21, 0xffff
    s_mov_b32 s34, 0xc00000
    s_mov_b32 s35, 0x20000
    s_mul_i32 s36, s9, 229376
    s_mul_i32 s12, s3, 28672
    s_add_u32 s36, s36, s12
    s_add_u32 s36, s36, 0
    s_add_u32 s37, s36, 114688
    s_mul_i32 s38, s8, 229376
    s_add_u32 s38, s38, s12
    s_add_u32 s38, s38, 7340032
    s_add_u32 s39, s38, 114688
    v_lshlrev_b32 v2, 4, v1
    buffer_load_dwordx4 v[40:43], v2, s[32:35], s36 offen offset:0
    buffer_load_dwordx4 v[48:51], v2, s[32:35], s38 offen offset:0
    buffer_load_dwordx4 v[44:47], v2, s[32:35], s37 offen offset:0
    buffer_load_dwordx4 v[52:55], v2, s[32:35], s39 offen offset:0
    buffer_load_dwordx4 v[56:59], v2, s[32:35], s36 offen offset:1024
    buffer_load_dwordx4 v[64:67], v2, s[32:35], s38 offen offset:1024
    buffer_load_dwordx4 v[60:63], v2, s[32:35], s37 offen offset:1024
    buffer_load_dwordx4 v[68:71], v2, s[32:35], s39 offen offset:1024
    buffer_load_dwordx4 v[72:75], v2, s[32:35], s36 offen offset:2048
    buffer_load_dwordx4 v[80:83], v2, s[32:35], s38 offen offset:2048
    buffer_load_dwordx4 v[76:79], v2, s[32:35], s37 offen offset:2048
    buffer_load_dwordx4 v[84:87], v2, s[32:35], s39 offen offset:2048
    buffer_load_dwordx4 v[88:91], v2, s[32:35], s36 offen offset:3072
    buffer_load_dwordx4 v[96:99], v2, s[32:35], s38 offen offset:3072
    buffer_load_dwordx4 v[92:95], v2, s[32:35], s37 offen offset:3072
    buffer_load_dwordx4 v[100:103], v2, s[32:35], s39 offen offset:3072
    s_add_u32 s36, s36, 4096
    s_add_u32 s37, s37, 4096
    s_add_u32 s38, s38, 4096
    s_add_u32 s39, s39, 4096
    buffer_load_dwordx4 v[104:107], v2, s[32:35], s36 offen offset:0
    buffer_load_dwordx4 v[112:115], v2, s[32:35], s38 offen offset:0
    buffer_load_dwordx4 v[108:111], v2, s[32:35], s37 offen offset:0
    buffer_load_dwordx4 v[116:119], v2, s[32:35], s39 offen offset:0
    buffer_load_dwordx4 v[120:123], v2, s[32:35], s36 offen offset:1024
    buffer_load_dwordx4 v[128:131], v2, s[32:35], s38 offen offset:1024
    buffer_load_dwordx4 v[124:127], v2, s[32:35], s37 offen offset:1024
    buffer_load_dwordx4 v[132:135], v2, s[32:35], s39 offen offset:1024
    buffer_load_dwordx4 v[136:139], v2, s[32:35], s36 offen offset:2048
    buffer_load_dwordx4 v[144:147], v2, s[32:35], s38 offen offset:2048
    buffer_load_dwordx4 v[140:143], v2, s[32:35], s37 offen offset:2048
    buffer_load_dwordx4 v[148:151], v2, s[32:35], s39 offen offset:2048
    buffer_load_dwordx4 v[152:155], v2, s[32:35], s36 offen offset:3072
    buffer_load_dwordx4 v[160:163], v2, s[32:35], s38 offen offset:3072
    buffer_load_dwordx4 v[156:159], v2, s[32:35], s37 offen offset:3072
    buffer_load_dwordx4 v[164:167], v2, s[32:35], s39 offen offset:3072
    s_add_u32 s36, s36, 4096
    s_add_u32 s37, s37, 4096
    s_add_u32 s38, s38, 4096
    s_add_u32 s39, s39, 4096
    s_mov_b32 s24, s16
    s_and_b32 s25, s17, 0xffff
    s_mov_b32 s26, 0x200000
    s_mov_b32 s27, 0x20000
    s_mov_b32 s28, s18
    s_and_b32 s29, s19, 0xffff
    s_mov_b32 s30, 0x200000
    s_mov_b32 s31, 0x20000
    s_lshl_b32 s12, s11, 14
    s_lshl_b32 s57, s10, 1
    s_add_u32 s57, s57, s6
    s_lshl_b32 s57, s57, 3
    s_add_u32 s57, s57, s8
    s_lshl_b32 s57, s57, 15
    s_add_u32 s57, s57, s12
    s_add_u32 s57, s57, 11272192
    v_and_b32 v3, 31, v1
    v_lshrrev_b32 v4, 5, v1
    s_lshl_b32 s12, s8, 5
    v_add_u32 v5, s12, v3
    v_mov_b32 v6, 256
    v_cmp_eq_u32 vcc, 0, v5
    s_nop 1
    v_cndmask_b32 v6, v5, v6, vcc
    v_sub_u32 v7, 512, v5
    v_and_b32 v7, 511, v7
    s_cmp_eq_u32 s11, 0
    s_cselect_b64 s[58:59], -1, 0
    s_nop 0
    v_cndmask_b32 v6, v7, v6, s[58:59]
    v_lshlrev_b32 v6, 1, v6
    v_mov_b32 v8, 1.0
    v_mov_b32 v9, 0
    s_andn2_b64 s[60:61], vcc, s[58:59]
    s_nop 1
    v_cndmask_b32 v8, v8, v9, s[60:61]
    s_lshl_b32 s12, s7, 6
    s_add_u32 s12, s12, s6
    v_lshlrev_b32 v9, 3, v4
    v_add_u32 v9, s12, v9
    v_sub_u32 v10, 1994, v9
    s_cmp_eq_u32 s10, 0
    s_cselect_b64 s[58:59], -1, 0
    s_nop 1
    v_cndmask_b32 v9, v10, v9, s[58:59]
    v_lshlrev_b32 v9, 10, v9
    v_add_u32 v9, v9, v6
    s_cmp_eq_u32 s9, 0
    s_cselect_b32 s12, s10, 0
    s_lshl_b32 s13, s12, 20
    v_mov_b32 v10, s13
    v_mov_b32 v11, 0
    v_cmp_eq_u32 vcc, 0, v4
    s_nop 1
    v_cndmask_b32 v10, v11, v10, vcc
    v_sub_u32 v10, v9, v10
    v_mov_b32 v12, s12
    v_cndmask_b32 v12, v11, v12, vcc

    s_mov_b32 s12, 0
    s_mov_b32 s13, 55296
    s_cmp_eq_u32 s10, 0
    s_cselect_b32 s40, s12, s13
    s_mov_b32 s12, 2048
    s_mov_b32 s13, 53248
    s_cmp_eq_u32 s10, 0
    s_cselect_b32 s41, s12, s13
    s_mov_b32 s12, 4096
    s_mov_b32 s13, 51200
    s_cmp_eq_u32 s10, 0
    s_cselect_b32 s42, s12, s13
    s_mov_b32 s12, 6144
    s_mov_b32 s13, 49152
    s_cmp_eq_u32 s10, 0
    s_cselect_b32 s43, s12, s13
    s_mov_b32 s12, 16384
    s_mov_b32 s13, 38912
    s_cmp_eq_u32 s10, 0
    s_cselect_b32 s44, s12, s13
    s_mov_b32 s12, 18432
    s_mov_b32 s13, 36864
    s_cmp_eq_u32 s10, 0
    s_cselect_b32 s45, s12, s13
    s_mov_b32 s12, 20480
    s_mov_b32 s13, 34816
    s_cmp_eq_u32 s10, 0
    s_cselect_b32 s46, s12, s13
    s_mov_b32 s12, 22528
    s_mov_b32 s13, 32768
    s_cmp_eq_u32 s10, 0
    s_cselect_b32 s47, s12, s13
    s_mov_b32 s12, 32768
    s_mov_b32 s13, 22528
    s_cmp_eq_u32 s10, 0
    s_cselect_b32 s48, s12, s13
    s_mov_b32 s12, 34816
    s_mov_b32 s13, 20480
    s_cmp_eq_u32 s10, 0
    s_cselect_b32 s49, s12, s13
    s_mov_b32 s12, 36864
    s_mov_b32 s13, 18432
    s_cmp_eq_u32 s10, 0
    s_cselect_b32 s50, s12, s13
    s_mov_b32 s12, 38912
    s_mov_b32 s13, 16384
    s_cmp_eq_u32 s10, 0
    s_cselect_b32 s51, s12, s13
    s_mov_b32 s12, 49152
    s_mov_b32 s13, 6144
    s_cmp_eq_u32 s10, 0
    s_cselect_b32 s52, s12, s13
    s_mov_b32 s12, 51200
    s_mov_b32 s13, 4096
    s_cmp_eq_u32 s10, 0
    s_cselect_b32 s53, s12, s13
    s_mov_b32 s12, 53248
    s_mov_b32 s13, 2048
    s_cmp_eq_u32 s10, 0
    s_cselect_b32 s54, s12, s13
    s_mov_b32 s12, 55296
    s_mov_b32 s13, 0
    s_cmp_eq_u32 s10, 0
    s_cselect_b32 s55, s12, s13
    s_lshl_b32 s12, s8, 7
    s_add_u32 s12, s12, 12320768
    v_lshlrev_b32 v11, 2, v3
    buffer_load_dword v13, v11, s[32:35], s12 offen
    buffer_load_ushort v20, v10, s[24:27], s40 offen
    buffer_load_ushort v21, v9, s[24:27], s41 offen
    buffer_load_ushort v22, v9, s[24:27], s42 offen
    buffer_load_ushort v23, v9, s[24:27], s43 offen
    buffer_load_ushort v24, v9, s[24:27], s44 offen
    buffer_load_ushort v25, v9, s[24:27], s45 offen
    buffer_load_ushort v26, v9, s[24:27], s46 offen
    buffer_load_ushort v27, v9, s[24:27], s47 offen
    buffer_load_ushort v28, v9, s[24:27], s48 offen
    buffer_load_ushort v29, v9, s[24:27], s49 offen
    buffer_load_ushort v30, v9, s[24:27], s50 offen
    buffer_load_ushort v31, v9, s[24:27], s51 offen
    buffer_load_ushort v32, v9, s[24:27], s52 offen
    buffer_load_ushort v33, v9, s[24:27], s53 offen
    buffer_load_ushort v34, v9, s[24:27], s54 offen
    buffer_load_ushort v35, v9, s[24:27], s55 offen
    v_mov_b32 v14, 0xBF803F80
    v_mov_b32 v15, 0
    v_cmp_eq_u32 vcc, 0, v3
    s_nop 1
    v_cndmask_b32 v16, v15, v14, vcc
    v_cndmask_b32 v17, v15, v14, vcc
    v_cndmask_b32 v18, v15, v14, vcc
    v_cndmask_b32 v19, v15, v14, vcc
    s_lshl_b32 s12, s3, 14
    v_add_u32 v11, s12, v2
    s_lshl_b32 s12, s3, 12
    s_add_u32 s13, s12, 65536
    v_add_u32 v14, s13, v2
    v_add_u32 v38, s12, v2
    s_lshl_b32 s12, s3, 8
    s_add_u32 s12, s12, 81920
    v_lshlrev_b32 v15, 2, v1
    v_add_u32 v15, s12, v15
    s_lshl_b32 s12, s7, 6
    s_add_u32 s12, s12, s6
    v_lshlrev_b32 v245, 1, v3
    v_add_u32 v245, s12, v245
    v_cvt_f32_u32 v245, v245
    v_mul_f32 v245, 0xba000000, v245
    s_lshl_b32 s12, s11, 8
    v_lshlrev_b32 v244, 2, v4
    v_add_u32 v244, s12, v244
    v_cvt_f32_u32 v244, v244
    s_cmp_eq_u32 s10, 0
    s_cselect_b32 s12, 0x3e800000, 0
    v_mov_b32 v246, s12
    v_fma_f32 v244, v245, v244, v246
    s_andn2_b32 s12, s10, s11
    s_cmp_eq_u32 s12, 1
    s_cselect_b32 s12, 0x44000000, 0
    v_mov_b32 v246, s12
    v_mov_b32 v247, 0
    v_cmp_eq_u32 vcc, 0, v4
    s_nop 1
    v_cndmask_b32 v246, v247, v246, vcc
    v_fma_f32 v246, v245, v246, v244
    v_mov_b32 v168, v246
    v_fmamk_f32 v169, v245, 0x3f800000, v244
    v_fmamk_f32 v170, v245, 0x40000000, v244
    v_fmamk_f32 v171, v245, 0x40400000, v244
    v_fmamk_f32 v172, v245, 0x41000000, v244
    v_fmamk_f32 v173, v245, 0x41100000, v244
    v_fmamk_f32 v174, v245, 0x41200000, v244
    v_fmamk_f32 v175, v245, 0x41300000, v244
    v_sin_f32 v168, v168
    v_sin_f32 v169, v169
    v_sin_f32 v170, v170
    v_sin_f32 v171, v171
    v_sin_f32 v172, v172
    v_sin_f32 v173, v173
    v_sin_f32 v174, v174
    v_sin_f32 v175, v175
    v_cvt_pk_bf16_f32 v240, v168, v169
    v_cvt_pk_bf16_f32 v241, v170, v171
    v_cvt_pk_bf16_f32 v242, v172, v173
    v_cvt_pk_bf16_f32 v243, v174, v175
    v_accvgpr_write_b32 a96, v240
    v_accvgpr_write_b32 a97, v241
    v_accvgpr_write_b32 a98, v242
    v_accvgpr_write_b32 a99, v243
    v_fmamk_f32 v168, v245, 0x41800000, v244
    v_fmamk_f32 v169, v245, 0x41880000, v244
    v_fmamk_f32 v170, v245, 0x41900000, v244
    v_fmamk_f32 v171, v245, 0x41980000, v244
    v_fmamk_f32 v172, v245, 0x41c00000, v244
    v_fmamk_f32 v173, v245, 0x41c80000, v244
    v_fmamk_f32 v174, v245, 0x41d00000, v244
    v_fmamk_f32 v175, v245, 0x41d80000, v244
    v_sin_f32 v168, v168
    v_sin_f32 v169, v169
    v_sin_f32 v170, v170
    v_sin_f32 v171, v171
    v_sin_f32 v172, v172
    v_sin_f32 v173, v173
    v_sin_f32 v174, v174
    v_sin_f32 v175, v175
    v_cvt_pk_bf16_f32 v240, v168, v169
    v_cvt_pk_bf16_f32 v241, v170, v171
    v_cvt_pk_bf16_f32 v242, v172, v173
    v_cvt_pk_bf16_f32 v243, v174, v175
    v_accvgpr_write_b32 a100, v240
    v_accvgpr_write_b32 a101, v241
    v_accvgpr_write_b32 a102, v242
    v_accvgpr_write_b32 a103, v243
    v_fmamk_f32 v168, v245, 0x42000000, v244
    v_fmamk_f32 v169, v245, 0x42040000, v244
    v_fmamk_f32 v170, v245, 0x42080000, v244
    v_fmamk_f32 v171, v245, 0x420c0000, v244
    v_fmamk_f32 v172, v245, 0x42200000, v244
    v_fmamk_f32 v173, v245, 0x42240000, v244
    v_fmamk_f32 v174, v245, 0x42280000, v244
    v_fmamk_f32 v175, v245, 0x422c0000, v244
    v_sin_f32 v168, v168
    v_sin_f32 v169, v169
    v_sin_f32 v170, v170
    v_sin_f32 v171, v171
    v_sin_f32 v172, v172
    v_sin_f32 v173, v173
    v_sin_f32 v174, v174
    v_sin_f32 v175, v175
    v_cvt_pk_bf16_f32 v240, v168, v169
    v_cvt_pk_bf16_f32 v241, v170, v171
    v_cvt_pk_bf16_f32 v242, v172, v173
    v_cvt_pk_bf16_f32 v243, v174, v175
    v_accvgpr_write_b32 a104, v240
    v_accvgpr_write_b32 a105, v241
    v_accvgpr_write_b32 a106, v242
    v_accvgpr_write_b32 a107, v243
    v_fmamk_f32 v168, v245, 0x42400000, v244
    v_fmamk_f32 v169, v245, 0x42440000, v244
    v_fmamk_f32 v170, v245, 0x42480000, v244
    v_fmamk_f32 v171, v245, 0x424c0000, v244
    v_fmamk_f32 v172, v245, 0x42600000, v244
    v_fmamk_f32 v173, v245, 0x42640000, v244
    v_fmamk_f32 v174, v245, 0x42680000, v244
    v_fmamk_f32 v175, v245, 0x426c0000, v244
    v_sin_f32 v168, v168
    v_sin_f32 v169, v169
    v_sin_f32 v170, v170
    v_sin_f32 v171, v171
    v_sin_f32 v172, v172
    v_sin_f32 v173, v173
    v_sin_f32 v174, v174
    v_sin_f32 v175, v175
    v_cvt_pk_bf16_f32 v240, v168, v169
    v_cvt_pk_bf16_f32 v241, v170, v171
    v_cvt_pk_bf16_f32 v242, v172, v173
    v_cvt_pk_bf16_f32 v243, v174, v175
    v_accvgpr_write_b32 a108, v240
    v_accvgpr_write_b32 a109, v241
    v_accvgpr_write_b32 a110, v242
    v_accvgpr_write_b32 a111, v243
    s_waitcnt vmcnt(45)
    v_mfma_f32_32x32x16_bf16 a[0:15], v[40:43], v[48:51], 0
    v_mfma_f32_32x32x16_bf16 a[16:31], v[40:43], v[52:55], 0
    v_mfma_f32_32x32x16_bf16 a[32:47], v[44:47], v[48:51], 0
    v_mfma_f32_32x32x16_bf16 a[48:63], v[44:47], v[52:55], 0
    buffer_load_dwordx4 v[40:43], v2, s[32:35], s36 offen offset:0
    buffer_load_dwordx4 v[48:51], v2, s[32:35], s38 offen offset:0
    buffer_load_dwordx4 v[44:47], v2, s[32:35], s37 offen offset:0
    buffer_load_dwordx4 v[52:55], v2, s[32:35], s39 offen offset:0
    v_fmamk_f32 v168, v245, 0x42800000, v244
    v_fmamk_f32 v169, v245, 0x42820000, v244
    v_fmamk_f32 v170, v245, 0x42840000, v244
    v_fmamk_f32 v171, v245, 0x42860000, v244
    v_fmamk_f32 v172, v245, 0x42900000, v244
    v_fmamk_f32 v173, v245, 0x42920000, v244
    v_fmamk_f32 v174, v245, 0x42940000, v244
    v_fmamk_f32 v175, v245, 0x42960000, v244
    v_sin_f32 v168, v168
    v_sin_f32 v169, v169
    v_sin_f32 v170, v170
    v_sin_f32 v171, v171
    v_sin_f32 v172, v172
    v_sin_f32 v173, v173
    v_sin_f32 v174, v174
    v_sin_f32 v175, v175
    v_cvt_pk_bf16_f32 v240, v168, v169
    v_cvt_pk_bf16_f32 v241, v170, v171
    v_cvt_pk_bf16_f32 v242, v172, v173
    v_cvt_pk_bf16_f32 v243, v174, v175
    v_accvgpr_write_b32 a112, v240
    v_accvgpr_write_b32 a113, v241
    v_accvgpr_write_b32 a114, v242
    v_accvgpr_write_b32 a115, v243
    s_waitcnt vmcnt(45)
    v_mfma_f32_32x32x16_bf16 a[0:15], v[56:59], v[64:67], a[0:15]
    v_mfma_f32_32x32x16_bf16 a[16:31], v[56:59], v[68:71], a[16:31]
    v_mfma_f32_32x32x16_bf16 a[32:47], v[60:63], v[64:67], a[32:47]
    v_mfma_f32_32x32x16_bf16 a[48:63], v[60:63], v[68:71], a[48:63]
    buffer_load_dwordx4 v[56:59], v2, s[32:35], s36 offen offset:1024
    buffer_load_dwordx4 v[64:67], v2, s[32:35], s38 offen offset:1024
    buffer_load_dwordx4 v[60:63], v2, s[32:35], s37 offen offset:1024
    buffer_load_dwordx4 v[68:71], v2, s[32:35], s39 offen offset:1024
    v_fmamk_f32 v168, v245, 0x42a00000, v244
    v_fmamk_f32 v169, v245, 0x42a20000, v244
    v_fmamk_f32 v170, v245, 0x42a40000, v244
    v_fmamk_f32 v171, v245, 0x42a60000, v244
    v_fmamk_f32 v172, v245, 0x42b00000, v244
    v_fmamk_f32 v173, v245, 0x42b20000, v244
    v_fmamk_f32 v174, v245, 0x42b40000, v244
    v_fmamk_f32 v175, v245, 0x42b60000, v244
    v_sin_f32 v168, v168
    v_sin_f32 v169, v169
    v_sin_f32 v170, v170
    v_sin_f32 v171, v171
    v_sin_f32 v172, v172
    v_sin_f32 v173, v173
    v_sin_f32 v174, v174
    v_sin_f32 v175, v175
    v_cvt_pk_bf16_f32 v240, v168, v169
    v_cvt_pk_bf16_f32 v241, v170, v171
    v_cvt_pk_bf16_f32 v242, v172, v173
    v_cvt_pk_bf16_f32 v243, v174, v175
    v_accvgpr_write_b32 a116, v240
    v_accvgpr_write_b32 a117, v241
    v_accvgpr_write_b32 a118, v242
    v_accvgpr_write_b32 a119, v243
    s_waitcnt vmcnt(45)
    v_mfma_f32_32x32x16_bf16 a[0:15], v[72:75], v[80:83], a[0:15]
    v_mfma_f32_32x32x16_bf16 a[16:31], v[72:75], v[84:87], a[16:31]
    v_mfma_f32_32x32x16_bf16 a[32:47], v[76:79], v[80:83], a[32:47]
    v_mfma_f32_32x32x16_bf16 a[48:63], v[76:79], v[84:87], a[48:63]
    buffer_load_dwordx4 v[76:79], v2, s[32:35], s57 offen offset:0
    buffer_load_dwordx4 v[84:87], v2, s[32:35], s57 offen offset:1024
    v_fmamk_f32 v168, v245, 0x42c00000, v244
    v_fmamk_f32 v169, v245, 0x42c20000, v244
    v_fmamk_f32 v170, v245, 0x42c40000, v244
    v_fmamk_f32 v171, v245, 0x42c60000, v244
    v_fmamk_f32 v172, v245, 0x42d00000, v244
    v_fmamk_f32 v173, v245, 0x42d20000, v244
    v_fmamk_f32 v174, v245, 0x42d40000, v244
    v_fmamk_f32 v175, v245, 0x42d60000, v244
    v_sin_f32 v168, v168
    v_sin_f32 v169, v169
    v_sin_f32 v170, v170
    v_sin_f32 v171, v171
    v_sin_f32 v172, v172
    v_sin_f32 v173, v173
    v_sin_f32 v174, v174
    v_sin_f32 v175, v175
    v_cvt_pk_bf16_f32 v240, v168, v169
    v_cvt_pk_bf16_f32 v241, v170, v171
    v_cvt_pk_bf16_f32 v242, v172, v173
    v_cvt_pk_bf16_f32 v243, v174, v175
    v_accvgpr_write_b32 a120, v240
    v_accvgpr_write_b32 a121, v241
    v_accvgpr_write_b32 a122, v242
    v_accvgpr_write_b32 a123, v243
    s_waitcnt vmcnt(43)
    v_mfma_f32_32x32x16_bf16 a[0:15], v[88:91], v[96:99], a[0:15]
    v_mfma_f32_32x32x16_bf16 a[16:31], v[88:91], v[100:103], a[16:31]
    v_mfma_f32_32x32x16_bf16 a[32:47], v[92:95], v[96:99], a[32:47]
    v_mfma_f32_32x32x16_bf16 a[48:63], v[92:95], v[100:103], a[48:63]
    buffer_load_dwordx4 v[92:95], v2, s[32:35], s57 offen offset:2048
    buffer_load_dwordx4 v[100:103], v2, s[32:35], s57 offen offset:3072
    s_add_u32 s57, s57, 4096
    v_fmamk_f32 v168, v245, 0x42e00000, v244
    v_fmamk_f32 v169, v245, 0x42e20000, v244
    v_fmamk_f32 v170, v245, 0x42e40000, v244
    v_fmamk_f32 v171, v245, 0x42e60000, v244
    v_fmamk_f32 v172, v245, 0x42f00000, v244
    v_fmamk_f32 v173, v245, 0x42f20000, v244
    v_fmamk_f32 v174, v245, 0x42f40000, v244
    v_fmamk_f32 v175, v245, 0x42f60000, v244
    v_sin_f32 v168, v168
    v_sin_f32 v169, v169
    v_sin_f32 v170, v170
    v_sin_f32 v171, v171
    v_sin_f32 v172, v172
    v_sin_f32 v173, v173
    v_sin_f32 v174, v174
    v_sin_f32 v175, v175
    v_cvt_pk_bf16_f32 v240, v168, v169
    v_cvt_pk_bf16_f32 v241, v170, v171
    v_cvt_pk_bf16_f32 v242, v172, v173
    v_cvt_pk_bf16_f32 v243, v174, v175
    v_accvgpr_write_b32 a124, v240
    v_accvgpr_write_b32 a125, v241
    v_accvgpr_write_b32 a126, v242
    v_accvgpr_write_b32 a127, v243
    s_waitcnt vmcnt(41)
    v_mfma_f32_32x32x16_bf16 a[0:15], v[104:107], v[112:115], a[0:15]
    v_mfma_f32_32x32x16_bf16 a[16:31], v[104:107], v[116:119], a[16:31]
    v_mfma_f32_32x32x16_bf16 a[32:47], v[108:111], v[112:115], a[32:47]
    v_mfma_f32_32x32x16_bf16 a[48:63], v[108:111], v[116:119], a[48:63]
    buffer_load_dwordx4 v[108:111], v2, s[32:35], s57 offen offset:0
    buffer_load_dwordx4 v[116:119], v2, s[32:35], s57 offen offset:1024
    v_fmamk_f32 v168, v245, 0x43000000, v244
    v_fmamk_f32 v169, v245, 0x43010000, v244
    v_fmamk_f32 v170, v245, 0x43020000, v244
    v_fmamk_f32 v171, v245, 0x43030000, v244
    v_fmamk_f32 v172, v245, 0x43080000, v244
    v_fmamk_f32 v173, v245, 0x43090000, v244
    v_fmamk_f32 v174, v245, 0x430a0000, v244
    v_fmamk_f32 v175, v245, 0x430b0000, v244
    v_sin_f32 v168, v168
    v_sin_f32 v169, v169
    v_sin_f32 v170, v170
    v_sin_f32 v171, v171
    v_sin_f32 v172, v172
    v_sin_f32 v173, v173
    v_sin_f32 v174, v174
    v_sin_f32 v175, v175
    v_cvt_pk_bf16_f32 v240, v168, v169
    v_cvt_pk_bf16_f32 v241, v170, v171
    v_cvt_pk_bf16_f32 v242, v172, v173
    v_cvt_pk_bf16_f32 v243, v174, v175
    v_accvgpr_write_b32 a128, v240
    v_accvgpr_write_b32 a129, v241
    v_accvgpr_write_b32 a130, v242
    v_accvgpr_write_b32 a131, v243
    s_waitcnt vmcnt(39)
    v_mfma_f32_32x32x16_bf16 a[0:15], v[120:123], v[128:131], a[0:15]
    v_mfma_f32_32x32x16_bf16 a[16:31], v[120:123], v[132:135], a[16:31]
    v_mfma_f32_32x32x16_bf16 a[32:47], v[124:127], v[128:131], a[32:47]
    v_mfma_f32_32x32x16_bf16 a[48:63], v[124:127], v[132:135], a[48:63]
    buffer_load_dwordx4 v[124:127], v2, s[32:35], s57 offen offset:2048
    buffer_load_dwordx4 v[132:135], v2, s[32:35], s57 offen offset:3072
    s_add_u32 s57, s57, 4096
    v_fmamk_f32 v168, v245, 0x43100000, v244
    v_fmamk_f32 v169, v245, 0x43110000, v244
    v_fmamk_f32 v170, v245, 0x43120000, v244
    v_fmamk_f32 v171, v245, 0x43130000, v244
    v_fmamk_f32 v172, v245, 0x43180000, v244
    v_fmamk_f32 v173, v245, 0x43190000, v244
    v_fmamk_f32 v174, v245, 0x431a0000, v244
    v_fmamk_f32 v175, v245, 0x431b0000, v244
    v_sin_f32 v168, v168
    v_sin_f32 v169, v169
    v_sin_f32 v170, v170
    v_sin_f32 v171, v171
    v_sin_f32 v172, v172
    v_sin_f32 v173, v173
    v_sin_f32 v174, v174
    v_sin_f32 v175, v175
    v_cvt_pk_bf16_f32 v240, v168, v169
    v_cvt_pk_bf16_f32 v241, v170, v171
    v_cvt_pk_bf16_f32 v242, v172, v173
    v_cvt_pk_bf16_f32 v243, v174, v175
    v_accvgpr_write_b32 a132, v240
    v_accvgpr_write_b32 a133, v241
    v_accvgpr_write_b32 a134, v242
    v_accvgpr_write_b32 a135, v243
    s_waitcnt vmcnt(37)
    v_mfma_f32_32x32x16_bf16 a[0:15], v[136:139], v[144:147], a[0:15]
    v_mfma_f32_32x32x16_bf16 a[16:31], v[136:139], v[148:151], a[16:31]
    v_mfma_f32_32x32x16_bf16 a[32:47], v[140:143], v[144:147], a[32:47]
    v_mfma_f32_32x32x16_bf16 a[48:63], v[140:143], v[148:151], a[48:63]
    buffer_load_dwordx4 v[140:143], v2, s[32:35], s57 offen offset:0
    buffer_load_dwordx4 v[148:151], v2, s[32:35], s57 offen offset:1024
    v_fmamk_f32 v168, v245, 0x43200000, v244
    v_fmamk_f32 v169, v245, 0x43210000, v244
    v_fmamk_f32 v170, v245, 0x43220000, v244
    v_fmamk_f32 v171, v245, 0x43230000, v244
    v_fmamk_f32 v172, v245, 0x43280000, v244
    v_fmamk_f32 v173, v245, 0x43290000, v244
    v_fmamk_f32 v174, v245, 0x432a0000, v244
    v_fmamk_f32 v175, v245, 0x432b0000, v244
    v_sin_f32 v168, v168
    v_sin_f32 v169, v169
    v_sin_f32 v170, v170
    v_sin_f32 v171, v171
    v_sin_f32 v172, v172
    v_sin_f32 v173, v173
    v_sin_f32 v174, v174
    v_sin_f32 v175, v175
    v_cvt_pk_bf16_f32 v240, v168, v169
    v_cvt_pk_bf16_f32 v241, v170, v171
    v_cvt_pk_bf16_f32 v242, v172, v173
    v_cvt_pk_bf16_f32 v243, v174, v175
    v_accvgpr_write_b32 a136, v240
    v_accvgpr_write_b32 a137, v241
    v_accvgpr_write_b32 a138, v242
    v_accvgpr_write_b32 a139, v243
    s_waitcnt vmcnt(35)
    v_mfma_f32_32x32x16_bf16 a[0:15], v[152:155], v[160:163], a[0:15]
    v_mfma_f32_32x32x16_bf16 a[16:31], v[152:155], v[164:167], a[16:31]
    v_mfma_f32_32x32x16_bf16 a[32:47], v[156:159], v[160:163], a[32:47]
    v_mfma_f32_32x32x16_bf16 a[48:63], v[156:159], v[164:167], a[48:63]
    buffer_load_dwordx4 v[156:159], v2, s[32:35], s57 offen offset:2048
    buffer_load_dwordx4 v[164:167], v2, s[32:35], s57 offen offset:3072
    s_add_u32 s57, s57, 4096
    v_fmamk_f32 v168, v245, 0x43300000, v244
    v_fmamk_f32 v169, v245, 0x43310000, v244
    v_fmamk_f32 v170, v245, 0x43320000, v244
    v_fmamk_f32 v171, v245, 0x43330000, v244
    v_fmamk_f32 v172, v245, 0x43380000, v244
    v_fmamk_f32 v173, v245, 0x43390000, v244
    v_fmamk_f32 v174, v245, 0x433a0000, v244
    v_fmamk_f32 v175, v245, 0x433b0000, v244
    v_sin_f32 v168, v168
    v_sin_f32 v169, v169
    v_sin_f32 v170, v170
    v_sin_f32 v171, v171
    v_sin_f32 v172, v172
    v_sin_f32 v173, v173
    v_sin_f32 v174, v174
    v_sin_f32 v175, v175
    v_cvt_pk_bf16_f32 v240, v168, v169
    v_cvt_pk_bf16_f32 v241, v170, v171
    v_cvt_pk_bf16_f32 v242, v172, v173
    v_cvt_pk_bf16_f32 v243, v174, v175
    v_accvgpr_write_b32 a140, v240
    v_accvgpr_write_b32 a141, v241
    v_accvgpr_write_b32 a142, v242
    v_accvgpr_write_b32 a143, v243
    s_waitcnt vmcnt(16)
    v_mfma_f32_32x32x16_bf16 a[0:15], v[40:43], v[48:51], a[0:15]
    v_mfma_f32_32x32x16_bf16 a[16:31], v[40:43], v[52:55], a[16:31]
    v_mfma_f32_32x32x16_bf16 a[32:47], v[44:47], v[48:51], a[32:47]
    v_mfma_f32_32x32x16_bf16 a[48:63], v[44:47], v[52:55], a[48:63]
    buffer_load_dwordx4 v[44:47], v2, s[32:35], s57 offen offset:0
    buffer_load_dwordx4 v[52:55], v2, s[32:35], s57 offen offset:1024
    v_fmamk_f32 v168, v245, 0x43400000, v244
    v_fmamk_f32 v169, v245, 0x43410000, v244
    v_fmamk_f32 v170, v245, 0x43420000, v244
    v_fmamk_f32 v171, v245, 0x43430000, v244
    v_fmamk_f32 v172, v245, 0x43480000, v244
    v_fmamk_f32 v173, v245, 0x43490000, v244
    v_fmamk_f32 v174, v245, 0x434a0000, v244
    v_fmamk_f32 v175, v245, 0x434b0000, v244
    v_sin_f32 v168, v168
    v_sin_f32 v169, v169
    v_sin_f32 v170, v170
    v_sin_f32 v171, v171
    v_sin_f32 v172, v172
    v_sin_f32 v173, v173
    v_sin_f32 v174, v174
    v_sin_f32 v175, v175
    v_cvt_pk_bf16_f32 v240, v168, v169
    v_cvt_pk_bf16_f32 v241, v170, v171
    v_cvt_pk_bf16_f32 v242, v172, v173
    v_cvt_pk_bf16_f32 v243, v174, v175
    v_accvgpr_write_b32 a144, v240
    v_accvgpr_write_b32 a145, v241
    v_accvgpr_write_b32 a146, v242
    v_accvgpr_write_b32 a147, v243
    s_waitcnt vmcnt(14)
    v_mfma_f32_32x32x16_bf16 a[0:15], v[56:59], v[64:67], a[0:15]
    v_mfma_f32_32x32x16_bf16 a[16:31], v[56:59], v[68:71], a[16:31]
    v_mfma_f32_32x32x16_bf16 a[32:47], v[60:63], v[64:67], a[32:47]
    v_mfma_f32_32x32x16_bf16 a[48:63], v[60:63], v[68:71], a[48:63]
    buffer_load_dwordx4 v[60:63], v2, s[32:35], s57 offen offset:2048
    buffer_load_dwordx4 v[68:71], v2, s[32:35], s57 offen offset:3072
    s_add_u32 s57, s57, 4096
    v_fmamk_f32 v168, v245, 0x43500000, v244
    v_fmamk_f32 v169, v245, 0x43510000, v244
    v_fmamk_f32 v170, v245, 0x43520000, v244
    v_fmamk_f32 v171, v245, 0x43530000, v244
    v_fmamk_f32 v172, v245, 0x43580000, v244
    v_fmamk_f32 v173, v245, 0x43590000, v244
    v_fmamk_f32 v174, v245, 0x435a0000, v244
    v_fmamk_f32 v175, v245, 0x435b0000, v244
    v_sin_f32 v168, v168
    v_sin_f32 v169, v169
    v_sin_f32 v170, v170
    v_sin_f32 v171, v171
    v_sin_f32 v172, v172
    v_sin_f32 v173, v173
    v_sin_f32 v174, v174
    v_sin_f32 v175, v175
    v_cvt_pk_bf16_f32 v240, v168, v169
    v_cvt_pk_bf16_f32 v241, v170, v171
    v_cvt_pk_bf16_f32 v242, v172, v173
    v_cvt_pk_bf16_f32 v243, v174, v175
    v_accvgpr_write_b32 a148, v240
    v_accvgpr_write_b32 a149, v241
    v_accvgpr_write_b32 a150, v242
    v_accvgpr_write_b32 a151, v243
    s_waitcnt vmcnt(14)
    v_mfma_f32_32x32x16_bf16 a[64:79], a[96:99], v[76:79], 0
    v_mfma_f32_32x32x16_bf16 a[80:95], v[16:19], v[76:79], 0
    v_mfma_f32_32x32x16_bf16 a[64:79], a[100:103], v[84:87], a[64:79]
    v_mfma_f32_32x32x16_bf16 a[80:95], v[16:19], v[84:87], a[80:95]
    buffer_load_dwordx4 v[72:75], v2, s[32:35], s36 offen offset:2048
    buffer_load_dwordx4 v[80:83], v2, s[32:35], s38 offen offset:2048
    buffer_load_dwordx4 v[76:79], v2, s[32:35], s37 offen offset:2048
    buffer_load_dwordx4 v[84:87], v2, s[32:35], s39 offen offset:2048
    v_fmamk_f32 v168, v245, 0x43600000, v244
    v_fmamk_f32 v169, v245, 0x43610000, v244
    v_fmamk_f32 v170, v245, 0x43620000, v244
    v_fmamk_f32 v171, v245, 0x43630000, v244
    v_fmamk_f32 v172, v245, 0x43680000, v244
    v_fmamk_f32 v173, v245, 0x43690000, v244
    v_fmamk_f32 v174, v245, 0x436a0000, v244
    v_fmamk_f32 v175, v245, 0x436b0000, v244
    v_sin_f32 v168, v168
    v_sin_f32 v169, v169
    v_sin_f32 v170, v170
    v_sin_f32 v171, v171
    v_sin_f32 v172, v172
    v_sin_f32 v173, v173
    v_sin_f32 v174, v174
    v_sin_f32 v175, v175
    v_cvt_pk_bf16_f32 v240, v168, v169
    v_cvt_pk_bf16_f32 v241, v170, v171
    v_cvt_pk_bf16_f32 v242, v172, v173
    v_cvt_pk_bf16_f32 v243, v174, v175
    v_accvgpr_write_b32 a152, v240
    v_accvgpr_write_b32 a153, v241
    v_accvgpr_write_b32 a154, v242
    v_accvgpr_write_b32 a155, v243
    s_waitcnt vmcnt(16)
    v_mfma_f32_32x32x16_bf16 a[64:79], a[104:107], v[92:95], a[64:79]
    v_mfma_f32_32x32x16_bf16 a[80:95], v[16:19], v[92:95], a[80:95]
    v_mfma_f32_32x32x16_bf16 a[64:79], a[108:111], v[100:103], a[64:79]
    v_mfma_f32_32x32x16_bf16 a[80:95], v[16:19], v[100:103], a[80:95]
    buffer_load_dwordx4 v[88:91], v2, s[32:35], s36 offen offset:3072
    buffer_load_dwordx4 v[96:99], v2, s[32:35], s38 offen offset:3072
    buffer_load_dwordx4 v[92:95], v2, s[32:35], s37 offen offset:3072
    buffer_load_dwordx4 v[100:103], v2, s[32:35], s39 offen offset:3072
    s_add_u32 s36, s36, 4096
    s_add_u32 s37, s37, 4096
    s_add_u32 s38, s38, 4096
    s_add_u32 s39, s39, 4096
    v_fmamk_f32 v168, v245, 0x43700000, v244
    v_fmamk_f32 v169, v245, 0x43710000, v244
    v_fmamk_f32 v170, v245, 0x43720000, v244
    v_fmamk_f32 v171, v245, 0x43730000, v244
    v_fmamk_f32 v172, v245, 0x43780000, v244
    v_fmamk_f32 v173, v245, 0x43790000, v244
    v_fmamk_f32 v174, v245, 0x437a0000, v244
    v_fmamk_f32 v175, v245, 0x437b0000, v244
    v_sin_f32 v168, v168
    v_sin_f32 v169, v169
    v_sin_f32 v170, v170
    v_sin_f32 v171, v171
    v_sin_f32 v172, v172
    v_sin_f32 v173, v173
    v_sin_f32 v174, v174
    v_sin_f32 v175, v175
    v_cvt_pk_bf16_f32 v240, v168, v169
    v_cvt_pk_bf16_f32 v241, v170, v171
    v_cvt_pk_bf16_f32 v242, v172, v173
    v_cvt_pk_bf16_f32 v243, v174, v175
    v_accvgpr_write_b32 a156, v240
    v_accvgpr_write_b32 a157, v241
    v_accvgpr_write_b32 a158, v242
    v_accvgpr_write_b32 a159, v243
    s_waitcnt vmcnt(18)
    v_mfma_f32_32x32x16_bf16 a[64:79], a[112:115], v[108:111], a[64:79]
    v_mfma_f32_32x32x16_bf16 a[80:95], v[16:19], v[108:111], a[80:95]
    v_mfma_f32_32x32x16_bf16 a[64:79], a[116:119], v[116:119], a[64:79]
    v_mfma_f32_32x32x16_bf16 a[80:95], v[16:19], v[116:119], a[80:95]
    buffer_load_dwordx4 v[104:107], v2, s[32:35], s36 offen offset:0
    buffer_load_dwordx4 v[112:115], v2, s[32:35], s38 offen offset:0
    buffer_load_dwordx4 v[108:111], v2, s[32:35], s37 offen offset:0
    buffer_load_dwordx4 v[116:119], v2, s[32:35], s39 offen offset:0
    s_waitcnt vmcnt(20)
    v_mfma_f32_32x32x16_bf16 a[64:79], a[120:123], v[124:127], a[64:79]
    v_mfma_f32_32x32x16_bf16 a[80:95], v[16:19], v[124:127], a[80:95]
    v_mfma_f32_32x32x16_bf16 a[64:79], a[124:127], v[132:135], a[64:79]
    v_mfma_f32_32x32x16_bf16 a[80:95], v[16:19], v[132:135], a[80:95]
    buffer_load_dwordx4 v[120:123], v2, s[32:35], s36 offen offset:1024
    buffer_load_dwordx4 v[128:131], v2, s[32:35], s38 offen offset:1024
    buffer_load_dwordx4 v[124:127], v2, s[32:35], s37 offen offset:1024
    buffer_load_dwordx4 v[132:135], v2, s[32:35], s39 offen offset:1024
    s_waitcnt vmcnt(22)
    v_mfma_f32_32x32x16_bf16 a[64:79], a[128:131], v[140:143], a[64:79]
    v_mfma_f32_32x32x16_bf16 a[80:95], v[16:19], v[140:143], a[80:95]
    v_mfma_f32_32x32x16_bf16 a[64:79], a[132:135], v[148:151], a[64:79]
    v_mfma_f32_32x32x16_bf16 a[80:95], v[16:19], v[148:151], a[80:95]
    buffer_load_dwordx4 v[136:139], v2, s[32:35], s36 offen offset:2048
    buffer_load_dwordx4 v[144:147], v2, s[32:35], s38 offen offset:2048
    buffer_load_dwordx4 v[140:143], v2, s[32:35], s37 offen offset:2048
    buffer_load_dwordx4 v[148:151], v2, s[32:35], s39 offen offset:2048
    s_waitcnt vmcnt(24)
    v_mfma_f32_32x32x16_bf16 a[64:79], a[136:139], v[156:159], a[64:79]
    v_mfma_f32_32x32x16_bf16 a[80:95], v[16:19], v[156:159], a[80:95]
    v_mfma_f32_32x32x16_bf16 a[64:79], a[140:143], v[164:167], a[64:79]
    v_mfma_f32_32x32x16_bf16 a[80:95], v[16:19], v[164:167], a[80:95]
    buffer_load_dwordx4 v[152:155], v2, s[32:35], s36 offen offset:3072
    buffer_load_dwordx4 v[160:163], v2, s[32:35], s38 offen offset:3072
    buffer_load_dwordx4 v[156:159], v2, s[32:35], s37 offen offset:3072
    buffer_load_dwordx4 v[164:167], v2, s[32:35], s39 offen offset:3072
    s_add_u32 s36, s36, 4096
    s_add_u32 s37, s37, 4096
    s_add_u32 s38, s38, 4096
    s_add_u32 s39, s39, 4096
    s_waitcnt vmcnt(26)
    v_mfma_f32_32x32x16_bf16 a[64:79], a[144:147], v[44:47], a[64:79]
    v_mfma_f32_32x32x16_bf16 a[80:95], v[16:19], v[44:47], a[80:95]
    v_mfma_f32_32x32x16_bf16 a[64:79], a[148:151], v[52:55], a[64:79]
    v_mfma_f32_32x32x16_bf16 a[80:95], v[16:19], v[52:55], a[80:95]
    buffer_load_dwordx4 v[40:43], v2, s[32:35], s36 offen offset:0
    buffer_load_dwordx4 v[48:51], v2, s[32:35], s38 offen offset:0
    buffer_load_dwordx4 v[44:47], v2, s[32:35], s37 offen offset:0
    buffer_load_dwordx4 v[52:55], v2, s[32:35], s39 offen offset:0
    s_waitcnt vmcnt(28)
    v_mfma_f32_32x32x16_bf16 a[64:79], a[152:155], v[60:63], a[64:79]
    v_mfma_f32_32x32x16_bf16 a[80:95], v[16:19], v[60:63], a[80:95]
    v_mfma_f32_32x32x16_bf16 a[64:79], a[156:159], v[68:71], a[64:79]
    v_mfma_f32_32x32x16_bf16 a[80:95], v[16:19], v[68:71], a[80:95]
    buffer_load_dwordx4 v[56:59], v2, s[32:35], s36 offen offset:1024
    buffer_load_dwordx4 v[64:67], v2, s[32:35], s38 offen offset:1024
    buffer_load_dwordx4 v[60:63], v2, s[32:35], s37 offen offset:1024
    buffer_load_dwordx4 v[68:71], v2, s[32:35], s39 offen offset:1024
    s_waitcnt vmcnt(28)
    v_mfma_f32_32x32x16_bf16 a[0:15], v[72:75], v[80:83], a[0:15]
    v_mfma_f32_32x32x16_bf16 a[16:31], v[72:75], v[84:87], a[16:31]
    v_mfma_f32_32x32x16_bf16 a[32:47], v[76:79], v[80:83], a[32:47]
    v_mfma_f32_32x32x16_bf16 a[48:63], v[76:79], v[84:87], a[48:63]
    buffer_load_dwordx4 v[72:75], v2, s[32:35], s36 offen offset:2048
    buffer_load_dwordx4 v[80:83], v2, s[32:35], s38 offen offset:2048
    buffer_load_dwordx4 v[76:79], v2, s[32:35], s37 offen offset:2048
    buffer_load_dwordx4 v[84:87], v2, s[32:35], s39 offen offset:2048
    s_nop 7
    s_nop 7
    ds_write_b128 v14, a[64:67] offset:0
    ds_write_b128 v14, a[68:71] offset:1024
    ds_write_b128 v14, a[72:75] offset:2048
    ds_write_b128 v14, a[76:79] offset:3072
    ds_write_b32 v15, a80
    v_add_u32 v14, 65536, v2
    v_lshlrev_b32 v15, 2, v3
    v_add_u32 v15, 81920, v15
    s_waitcnt vmcnt(28)
    v_mfma_f32_32x32x16_bf16 a[0:15], v[88:91], v[96:99], a[0:15]
    v_mfma_f32_32x32x16_bf16 a[16:31], v[88:91], v[100:103], a[16:31]
    v_mfma_f32_32x32x16_bf16 a[32:47], v[92:95], v[96:99], a[32:47]
    v_mfma_f32_32x32x16_bf16 a[48:63], v[92:95], v[100:103], a[48:63]
    buffer_load_dwordx4 v[88:91], v2, s[32:35], s36 offen offset:3072
    buffer_load_dwordx4 v[96:99], v2, s[32:35], s38 offen offset:3072
    buffer_load_dwordx4 v[92:95], v2, s[32:35], s37 offen offset:3072
    buffer_load_dwordx4 v[100:103], v2, s[32:35], s39 offen offset:3072
    s_add_u32 s36, s36, 4096
    s_add_u32 s37, s37, 4096
    s_add_u32 s38, s38, 4096
    s_add_u32 s39, s39, 4096
    s_waitcnt vmcnt(28)
    v_mfma_f32_32x32x16_bf16 a[0:15], v[104:107], v[112:115], a[0:15]
    v_mfma_f32_32x32x16_bf16 a[16:31], v[104:107], v[116:119], a[16:31]
    v_mfma_f32_32x32x16_bf16 a[32:47], v[108:111], v[112:115], a[32:47]
    v_mfma_f32_32x32x16_bf16 a[48:63], v[108:111], v[116:119], a[48:63]
    buffer_load_dwordx4 v[104:107], v2, s[32:35], s36 offen offset:0
    buffer_load_dwordx4 v[112:115], v2, s[32:35], s38 offen offset:0
    buffer_load_dwordx4 v[108:111], v2, s[32:35], s37 offen offset:0
    buffer_load_dwordx4 v[116:119], v2, s[32:35], s39 offen offset:0
    s_waitcnt lgkmcnt(0)
    s_barrier
    ds_read_b128 v[176:179], v14 offset:0
    ds_read_b128 v[180:183], v14 offset:1024
    ds_read_b128 v[184:187], v14 offset:2048
    ds_read_b128 v[188:191], v14 offset:3072
    ds_read_b128 v[192:195], v14 offset:4096
    ds_read_b128 v[196:199], v14 offset:5120
    ds_read_b128 v[200:203], v14 offset:6144
    ds_read_b128 v[204:207], v14 offset:7168
    ds_read_b128 v[208:211], v14 offset:8192
    ds_read_b128 v[212:215], v14 offset:9216
    ds_read_b128 v[216:219], v14 offset:10240
    ds_read_b128 v[220:223], v14 offset:11264
    ds_read_b128 v[224:227], v14 offset:12288
    ds_read_b128 v[228:231], v14 offset:13312
    ds_read_b128 v[232:235], v14 offset:14336
    ds_read_b128 v[236:239], v14 offset:15360
    ds_read_b32 v36, v15
    ds_read_b32 v37, v15 offset:256
    s_waitcnt vmcnt(28)
    v_mfma_f32_32x32x16_bf16 a[0:15], v[120:123], v[128:131], a[0:15]
    v_mfma_f32_32x32x16_bf16 a[16:31], v[120:123], v[132:135], a[16:31]
    v_mfma_f32_32x32x16_bf16 a[32:47], v[124:127], v[128:131], a[32:47]
    v_mfma_f32_32x32x16_bf16 a[48:63], v[124:127], v[132:135], a[48:63]
    buffer_load_dwordx4 v[120:123], v2, s[32:35], s36 offen offset:1024
    buffer_load_dwordx4 v[128:131], v2, s[32:35], s38 offen offset:1024
    buffer_load_dwordx4 v[124:127], v2, s[32:35], s37 offen offset:1024
    buffer_load_dwordx4 v[132:135], v2, s[32:35], s39 offen offset:1024
    s_waitcnt vmcnt(28)
    v_mfma_f32_32x32x16_bf16 a[0:15], v[136:139], v[144:147], a[0:15]
    v_mfma_f32_32x32x16_bf16 a[16:31], v[136:139], v[148:151], a[16:31]
    v_mfma_f32_32x32x16_bf16 a[32:47], v[140:143], v[144:147], a[32:47]
    v_mfma_f32_32x32x16_bf16 a[48:63], v[140:143], v[148:151], a[48:63]
    buffer_load_dwordx4 v[136:139], v2, s[32:35], s36 offen offset:2048
    buffer_load_dwordx4 v[144:147], v2, s[32:35], s38 offen offset:2048
    buffer_load_dwordx4 v[140:143], v2, s[32:35], s37 offen offset:2048
    buffer_load_dwordx4 v[148:151], v2, s[32:35], s39 offen offset:2048
    s_waitcnt vmcnt(63)
    s_cmp_eq_u32 s10, s11
    s_cselect_b32 s12, 0xbf800000, 0x3f800000
    s_cmp_eq_u32 s6, 0
    s_cselect_b32 s13, 0x3f800000, 0
    v_mul_f32 v13, s13, v13
    s_waitcnt lgkmcnt(0)
    v_pk_add_f32 v[176:177], v[176:177], v[192:193]
    v_pk_add_f32 v[208:209], v[208:209], v[224:225]
    v_pk_add_f32 v[178:179], v[178:179], v[194:195]
    v_pk_add_f32 v[210:211], v[210:211], v[226:227]
    v_pk_add_f32 v[180:181], v[180:181], v[196:197]
    v_pk_add_f32 v[212:213], v[212:213], v[228:229]
    v_pk_add_f32 v[182:183], v[182:183], v[198:199]
    v_pk_add_f32 v[214:215], v[214:215], v[230:231]
    v_pk_add_f32 v[184:185], v[184:185], v[200:201]
    v_pk_add_f32 v[216:217], v[216:217], v[232:233]
    v_pk_add_f32 v[186:187], v[186:187], v[202:203]
    v_pk_add_f32 v[218:219], v[218:219], v[234:235]
    v_pk_add_f32 v[188:189], v[188:189], v[204:205]
    v_pk_add_f32 v[220:221], v[220:221], v[236:237]
    v_pk_add_f32 v[190:191], v[190:191], v[206:207]
    v_pk_add_f32 v[222:223], v[222:223], v[238:239]
    v_add_f32 v176, v176, v13
    v_sub_f32 v177, v177, v13
    v_add_f32 v178, v178, v13
    v_sub_f32 v179, v179, v13
    v_add_f32 v180, v180, v13
    v_sub_f32 v181, v181, v13
    v_add_f32 v182, v182, v13
    v_sub_f32 v183, v183, v13
    v_add_f32 v184, v184, v13
    v_sub_f32 v185, v185, v13
    v_add_f32 v186, v186, v13
    v_sub_f32 v187, v187, v13
    v_add_f32 v188, v188, v13
    v_sub_f32 v189, v189, v13
    v_add_f32 v190, v190, v13
    v_sub_f32 v191, v191, v13
    v_fma_f32 v176, s12, v208, v176
    v_fma_f32 v177, s12, v209, v177
    v_fma_f32 v178, s12, v210, v178
    v_fma_f32 v179, s12, v211, v179
    v_fma_f32 v180, s12, v212, v180
    v_fma_f32 v181, s12, v213, v181
    v_fma_f32 v182, s12, v214, v182
    v_fma_f32 v183, s12, v215, v183
    v_fma_f32 v184, s12, v216, v184
    v_fma_f32 v185, s12, v217, v185
    v_fma_f32 v186, s12, v218, v186
    v_fma_f32 v187, s12, v219, v187
    v_fma_f32 v188, s12, v220, v188
    v_fma_f32 v189, s12, v221, v189
    v_fma_f32 v190, s12, v222, v190
    v_fma_f32 v191, s12, v223, v191
    v_add_f32 v36, v36, v37
    v_add_f32 v36, v36, v13
    v_cmp_ne_u32 vcc, 0, v12
    s_nop 1
    v_cndmask_b32 v176, v176, v36, vcc
    v_mul_f32 v240, v176, v8
    v_lshlrev_b32 v20, 16, v20
    v_mul_f32 v241, v177, v8
    v_lshlrev_b32 v21, 16, v21
    v_mul_f32 v242, v178, v8
    v_lshlrev_b32 v22, 16, v22
    v_mul_f32 v243, v179, v8
    v_lshlrev_b32 v23, 16, v23
    v_mul_f32 v244, v180, v8
    v_lshlrev_b32 v24, 16, v24
    v_mul_f32 v245, v181, v8
    v_lshlrev_b32 v25, 16, v25
    v_mul_f32 v246, v182, v8
    v_lshlrev_b32 v26, 16, v26
    v_mul_f32 v247, v183, v8
    v_lshlrev_b32 v27, 16, v27
    v_mul_f32 v248, v184, v8
    v_lshlrev_b32 v28, 16, v28
    v_mul_f32 v249, v185, v8
    v_lshlrev_b32 v29, 16, v29
    v_mul_f32 v250, v186, v8
    v_lshlrev_b32 v30, 16, v30
    v_mul_f32 v251, v187, v8
    v_lshlrev_b32 v31, 16, v31
    v_mul_f32 v252, v188, v8
    v_lshlrev_b32 v32, 16, v32
    v_mul_f32 v253, v189, v8
    v_lshlrev_b32 v33, 16, v33
    v_mul_f32 v254, v190, v8
    v_lshlrev_b32 v34, 16, v34
    v_mul_f32 v255, v191, v8
    v_lshlrev_b32 v35, 16, v35
    s_add_u32 s12, s3, 1
    s_and_b32 s12, s12, 3
    s_lshl_b32 s12, s12, 14
    v_add_u32 v168, s12, v38
    s_add_u32 s12, s3, 2
    s_and_b32 s12, s12, 3
    s_lshl_b32 s12, s12, 14
    v_add_u32 v169, s12, v38
    s_add_u32 s12, s3, 3
    s_and_b32 s12, s12, 3
    s_lshl_b32 s12, s12, 14
    v_add_u32 v170, s12, v38
    s_mov_b32 s12, 0xbfb8aa3b
    s_mov_b32 s13, 0xbfb8aa3b
    s_mov_b32 s14, 1.0
    s_mov_b32 s15, 1.0
    s_waitcnt vmcnt(28)
    v_mfma_f32_32x32x16_bf16 a[0:15], v[152:155], v[160:163], a[0:15]
    v_mfma_f32_32x32x16_bf16 a[16:31], v[152:155], v[164:167], a[16:31]
    v_mfma_f32_32x32x16_bf16 a[32:47], v[156:159], v[160:163], a[32:47]
    v_mfma_f32_32x32x16_bf16 a[48:63], v[156:159], v[164:167], a[48:63]
    buffer_load_dwordx4 v[152:155], v2, s[32:35], s36 offen offset:3072
    buffer_load_dwordx4 v[160:163], v2, s[32:35], s38 offen offset:3072
    buffer_load_dwordx4 v[156:159], v2, s[32:35], s37 offen offset:3072
    buffer_load_dwordx4 v[164:167], v2, s[32:35], s39 offen offset:3072
    s_add_u32 s36, s36, 4096
    s_add_u32 s37, s37, 4096
    s_add_u32 s38, s38, 4096
    s_add_u32 s39, s39, 4096
    s_waitcnt vmcnt(28)
    v_mfma_f32_32x32x16_bf16 a[0:15], v[40:43], v[48:51], a[0:15]
    v_mfma_f32_32x32x16_bf16 a[16:31], v[40:43], v[52:55], a[16:31]
    v_mfma_f32_32x32x16_bf16 a[32:47], v[44:47], v[48:51], a[32:47]
    v_mfma_f32_32x32x16_bf16 a[48:63], v[44:47], v[52:55], a[48:63]
    buffer_load_dwordx4 v[40:43], v2, s[32:35], s36 offen offset:0
    buffer_load_dwordx4 v[48:51], v2, s[32:35], s38 offen offset:0
    buffer_load_dwordx4 v[44:47], v2, s[32:35], s37 offen offset:0
    buffer_load_dwordx4 v[52:55], v2, s[32:35], s39 offen offset:0
    s_waitcnt vmcnt(28)
    v_mfma_f32_32x32x16_bf16 a[0:15], v[56:59], v[64:67], a[0:15]
    v_mfma_f32_32x32x16_bf16 a[16:31], v[56:59], v[68:71], a[16:31]
    v_mfma_f32_32x32x16_bf16 a[32:47], v[60:63], v[64:67], a[32:47]
    v_mfma_f32_32x32x16_bf16 a[48:63], v[60:63], v[68:71], a[48:63]
    buffer_load_dwordx4 v[56:59], v2, s[32:35], s36 offen offset:1024
    buffer_load_dwordx4 v[64:67], v2, s[32:35], s38 offen offset:1024
    buffer_load_dwordx4 v[60:63], v2, s[32:35], s37 offen offset:1024
    buffer_load_dwordx4 v[68:71], v2, s[32:35], s39 offen offset:1024
    s_waitcnt vmcnt(28)
    v_mfma_f32_32x32x16_bf16 a[0:15], v[72:75], v[80:83], a[0:15]
    v_mfma_f32_32x32x16_bf16 a[16:31], v[72:75], v[84:87], a[16:31]
    v_mfma_f32_32x32x16_bf16 a[32:47], v[76:79], v[80:83], a[32:47]
    v_mfma_f32_32x32x16_bf16 a[48:63], v[76:79], v[84:87], a[48:63]
    buffer_load_dwordx4 v[72:75], v2, s[32:35], s36 offen offset:2048
    buffer_load_dwordx4 v[80:83], v2, s[32:35], s38 offen offset:2048
    buffer_load_dwordx4 v[76:79], v2, s[32:35], s37 offen offset:2048
    buffer_load_dwordx4 v[84:87], v2, s[32:35], s39 offen offset:2048
    s_waitcnt vmcnt(28)
    v_mfma_f32_32x32x16_bf16 a[0:15], v[88:91], v[96:99], a[0:15]
    v_mfma_f32_32x32x16_bf16 a[16:31], v[88:91], v[100:103], a[16:31]
    v_mfma_f32_32x32x16_bf16 a[32:47], v[92:95], v[96:99], a[32:47]
    v_mfma_f32_32x32x16_bf16 a[48:63], v[92:95], v[100:103], a[48:63]
    buffer_load_dwordx4 v[88:91], v2, s[32:35], s36 offen offset:3072
    buffer_load_dwordx4 v[96:99], v2, s[32:35], s38 offen offset:3072
    buffer_load_dwordx4 v[92:95], v2, s[32:35], s37 offen offset:3072
    buffer_load_dwordx4 v[100:103], v2, s[32:35], s39 offen offset:3072
    s_add_u32 s36, s36, 4096
    s_add_u32 s37, s37, 4096
    s_add_u32 s38, s38, 4096
    s_add_u32 s39, s39, 4096
    s_waitcnt vmcnt(28)
    v_mfma_f32_32x32x16_bf16 a[0:15], v[104:107], v[112:115], a[0:15]
    v_mfma_f32_32x32x16_bf16 a[16:31], v[104:107], v[116:119], a[16:31]
    v_mfma_f32_32x32x16_bf16 a[32:47], v[108:111], v[112:115], a[32:47]
    v_mfma_f32_32x32x16_bf16 a[48:63], v[108:111], v[116:119], a[48:63]
    s_waitcnt vmcnt(24)
    v_mfma_f32_32x32x16_bf16 a[0:15], v[120:123], v[128:131], a[0:15]
    v_mfma_f32_32x32x16_bf16 a[16:31], v[120:123], v[132:135], a[16:31]
    v_mfma_f32_32x32x16_bf16 a[32:47], v[124:127], v[128:131], a[32:47]
    v_mfma_f32_32x32x16_bf16 a[48:63], v[124:127], v[132:135], a[48:63]
    s_waitcnt vmcnt(20)
    v_mfma_f32_32x32x16_bf16 a[0:15], v[136:139], v[144:147], a[0:15]
    v_mfma_f32_32x32x16_bf16 a[16:31], v[136:139], v[148:151], a[16:31]
    v_mfma_f32_32x32x16_bf16 a[32:47], v[140:143], v[144:147], a[32:47]
    v_mfma_f32_32x32x16_bf16 a[48:63], v[140:143], v[148:151], a[48:63]
    s_waitcnt vmcnt(16)
    v_mfma_f32_32x32x16_bf16 a[0:15], v[152:155], v[160:163], a[0:15]
    v_mfma_f32_32x32x16_bf16 a[16:31], v[152:155], v[164:167], a[16:31]
    v_mfma_f32_32x32x16_bf16 a[32:47], v[156:159], v[160:163], a[32:47]
    v_mfma_f32_32x32x16_bf16 a[48:63], v[156:159], v[164:167], a[48:63]
    s_waitcnt vmcnt(12)
    v_mfma_f32_32x32x16_bf16 a[0:15], v[40:43], v[48:51], a[0:15]
    v_mfma_f32_32x32x16_bf16 a[16:31], v[40:43], v[52:55], a[16:31]
    v_mfma_f32_32x32x16_bf16 a[32:47], v[44:47], v[48:51], a[32:47]
    v_mfma_f32_32x32x16_bf16 a[48:63], v[44:47], v[52:55], a[48:63]
    s_waitcnt vmcnt(8)
    v_mfma_f32_32x32x16_bf16 a[0:15], v[56:59], v[64:67], a[0:15]
    v_mfma_f32_32x32x16_bf16 a[16:31], v[56:59], v[68:71], a[16:31]
    v_mfma_f32_32x32x16_bf16 a[32:47], v[60:63], v[64:67], a[32:47]
    v_mfma_f32_32x32x16_bf16 a[48:63], v[60:63], v[68:71], a[48:63]
    s_waitcnt vmcnt(4)
    v_mfma_f32_32x32x16_bf16 a[0:15], v[72:75], v[80:83], a[0:15]
    v_mfma_f32_32x32x16_bf16 a[16:31], v[72:75], v[84:87], a[16:31]
    v_mfma_f32_32x32x16_bf16 a[32:47], v[76:79], v[80:83], a[32:47]
    v_mfma_f32_32x32x16_bf16 a[48:63], v[76:79], v[84:87], a[48:63]
    s_waitcnt vmcnt(0)
    v_mfma_f32_32x32x16_bf16 a[0:15], v[88:91], v[96:99], a[0:15]
    v_mfma_f32_32x32x16_bf16 a[16:31], v[88:91], v[100:103], a[16:31]
    v_mfma_f32_32x32x16_bf16 a[32:47], v[92:95], v[96:99], a[32:47]
    v_mfma_f32_32x32x16_bf16 a[48:63], v[92:95], v[100:103], a[48:63]
    s_nop 7
    s_nop 7
    s_cmp_eq_u32 s3, 0
    s_cbranch_scc0 K2_TW1
    ds_write_b128 v11, a[16:19] offset:4096
    ds_write_b128 v11, a[20:23] offset:5120
    ds_write_b128 v11, a[24:27] offset:6144
    ds_write_b128 v11, a[28:31] offset:7168
    ds_write_b128 v11, a[32:35] offset:8192
    ds_write_b128 v11, a[36:39] offset:9216
    ds_write_b128 v11, a[40:43] offset:10240
    ds_write_b128 v11, a[44:47] offset:11264
    ds_write_b128 v11, a[48:51] offset:12288
    ds_write_b128 v11, a[52:55] offset:13312
    ds_write_b128 v11, a[56:59] offset:14336
    ds_write_b128 v11, a[60:63] offset:15360
    v_accvgpr_read_b32 v176, a0
    v_accvgpr_read_b32 v177, a1
    v_accvgpr_read_b32 v178, a2
    v_accvgpr_read_b32 v179, a3
    v_accvgpr_read_b32 v180, a4
    v_accvgpr_read_b32 v181, a5
    v_accvgpr_read_b32 v182, a6
    v_accvgpr_read_b32 v183, a7
    v_accvgpr_read_b32 v184, a8
    v_accvgpr_read_b32 v185, a9
    v_accvgpr_read_b32 v186, a10
    v_accvgpr_read_b32 v187, a11
    v_accvgpr_read_b32 v188, a12
    v_accvgpr_read_b32 v189, a13
    v_accvgpr_read_b32 v190, a14
    v_accvgpr_read_b32 v191, a15
    s_branch K2_TWE
K2_TW1:
    s_cmp_eq_u32 s3, 1
    s_cbranch_scc0 K2_TW2
    ds_write_b128 v11, a[0:3] offset:0
    ds_write_b128 v11, a[4:7] offset:1024
    ds_write_b128 v11, a[8:11] offset:2048
    ds_write_b128 v11, a[12:15] offset:3072
    ds_write_b128 v11, a[32:35] offset:8192
    ds_write_b128 v11, a[36:39] offset:9216
    ds_write_b128 v11, a[40:43] offset:10240
    ds_write_b128 v11, a[44:47] offset:11264
    ds_write_b128 v11, a[48:51] offset:12288
    ds_write_b128 v11, a[52:55] offset:13312
    ds_write_b128 v11, a[56:59] offset:14336
    ds_write_b128 v11, a[60:63] offset:15360
    v_accvgpr_read_b32 v176, a16
    v_accvgpr_read_b32 v177, a17
    v_accvgpr_read_b32 v178, a18
    v_accvgpr_read_b32 v179, a19
    v_accvgpr_read_b32 v180, a20
    v_accvgpr_read_b32 v181, a21
    v_accvgpr_read_b32 v182, a22
    v_accvgpr_read_b32 v183, a23
    v_accvgpr_read_b32 v184, a24
    v_accvgpr_read_b32 v185, a25
    v_accvgpr_read_b32 v186, a26
    v_accvgpr_read_b32 v187, a27
    v_accvgpr_read_b32 v188, a28
    v_accvgpr_read_b32 v189, a29
    v_accvgpr_read_b32 v190, a30
    v_accvgpr_read_b32 v191, a31
    s_branch K2_TWE
K2_TW2:
    s_cmp_eq_u32 s3, 2
    s_cbranch_scc0 K2_TW3
    ds_write_b128 v11, a[0:3] offset:0
    ds_write_b128 v11, a[4:7] offset:1024
    ds_write_b128 v11, a[8:11] offset:2048
    ds_write_b128 v11, a[12:15] offset:3072
    ds_write_b128 v11, a[16:19] offset:4096
    ds_write_b128 v11, a[20:23] offset:5120
    ds_write_b128 v11, a[24:27] offset:6144
    ds_write_b128 v11, a[28:31] offset:7168
    ds_write_b128 v11, a[48:51] offset:12288
    ds_write_b128 v11, a[52:55] offset:13312
    ds_write_b128 v11, a[56:59] offset:14336
    ds_write_b128 v11, a[60:63] offset:15360
    v_accvgpr_read_b32 v176, a32
    v_accvgpr_read_b32 v177, a33
    v_accvgpr_read_b32 v178, a34
    v_accvgpr_read_b32 v179, a35
    v_accvgpr_read_b32 v180, a36
    v_accvgpr_read_b32 v181, a37
    v_accvgpr_read_b32 v182, a38
    v_accvgpr_read_b32 v183, a39
    v_accvgpr_read_b32 v184, a40
    v_accvgpr_read_b32 v185, a41
    v_accvgpr_read_b32 v186, a42
    v_accvgpr_read_b32 v187, a43
    v_accvgpr_read_b32 v188, a44
    v_accvgpr_read_b32 v189, a45
    v_accvgpr_read_b32 v190, a46
    v_accvgpr_read_b32 v191, a47
    s_branch K2_TWE
K2_TW3:
    ds_write_b128 v11, a[0:3] offset:0
    ds_write_b128 v11, a[4:7] offset:1024
    ds_write_b128 v11, a[8:11] offset:2048
    ds_write_b128 v11, a[12:15] offset:3072
    ds_write_b128 v11, a[16:19] offset:4096
    ds_write_b128 v11, a[20:23] offset:5120
    ds_write_b128 v11, a[24:27] offset:6144
    ds_write_b128 v11, a[28:31] offset:7168
    ds_write_b128 v11, a[32:35] offset:8192
    ds_write_b128 v11, a[36:39] offset:9216
    ds_write_b128 v11, a[40:43] offset:10240
    ds_write_b128 v11, a[44:47] offset:11264
    v_accvgpr_read_b32 v176, a48
    v_accvgpr_read_b32 v177, a49
    v_accvgpr_read_b32 v178, a50
    v_accvgpr_read_b32 v179, a51
    v_accvgpr_read_b32 v180, a52
    v_accvgpr_read_b32 v181, a53
    v_accvgpr_read_b32 v182, a54
    v_accvgpr_read_b32 v183, a55
    v_accvgpr_read_b32 v184, a56
    v_accvgpr_read_b32 v185, a57
    v_accvgpr_read_b32 v186, a58
    v_accvgpr_read_b32 v187, a59
    v_accvgpr_read_b32 v188, a60
    v_accvgpr_read_b32 v189, a61
    v_accvgpr_read_b32 v190, a62
    v_accvgpr_read_b32 v191, a63
K2_TWE:
    s_waitcnt lgkmcnt(0)
    s_barrier
    ds_read_b128 v[192:195], v168 offset:0
    ds_read_b128 v[208:211], v169 offset:0
    ds_read_b128 v[224:227], v170 offset:0
    ds_read_b128 v[196:199], v168 offset:1024
    ds_read_b128 v[212:215], v169 offset:1024
    ds_read_b128 v[228:231], v170 offset:1024
    ds_read_b128 v[200:203], v168 offset:2048
    ds_read_b128 v[216:219], v169 offset:2048
    ds_read_b128 v[232:235], v170 offset:2048
    ds_read_b128 v[204:207], v168 offset:3072
    ds_read_b128 v[220:223], v169 offset:3072
    ds_read_b128 v[236:239], v170 offset:3072
    s_waitcnt lgkmcnt(9)
    v_pk_add_f32 v[176:177], v[176:177], v[192:193]
    v_pk_add_f32 v[208:209], v[208:209], v[224:225]
    v_pk_add_f32 v[178:179], v[178:179], v[194:195]
    v_pk_add_f32 v[210:211], v[210:211], v[226:227]
    v_pk_add_f32 v[176:177], v[176:177], v[208:209]
    v_pk_add_f32 v[178:179], v[178:179], v[210:211]
    v_pk_mul_f32 v[40:41], v[176:177], s[12:13]
    v_pk_mul_f32 v[42:43], v[178:179], s[12:13]
    v_exp_f32 v40, v40
    v_exp_f32 v41, v41
    v_exp_f32 v42, v42
    v_exp_f32 v43, v43
    v_pk_mul_f32 v[176:177], v[176:177], v[240:241]
    v_pk_mul_f32 v[178:179], v[178:179], v[242:243]
    v_pk_add_f32 v[40:41], v[40:41], s[14:15]
    v_pk_add_f32 v[42:43], v[42:43], s[14:15]
    v_rcp_f32 v40, v40
    v_rcp_f32 v41, v41
    v_rcp_f32 v42, v42
    v_rcp_f32 v43, v43
    s_nop 0
    v_pk_fma_f32 v[176:177], v[176:177], v[40:41], v[20:21]
    v_pk_fma_f32 v[178:179], v[178:179], v[42:43], v[22:23]
    v_cvt_pk_bf16_f32 v176, v176, v177
    v_cvt_pk_bf16_f32 v178, v178, v179
    buffer_store_short v176, v10, s[28:31], s40 offen
    buffer_store_short_d16_hi v176, v9, s[28:31], s41 offen
    buffer_store_short v178, v9, s[28:31], s42 offen
    buffer_store_short_d16_hi v178, v9, s[28:31], s43 offen
    s_waitcnt lgkmcnt(6)
    v_pk_add_f32 v[180:181], v[180:181], v[196:197]
    v_pk_add_f32 v[212:213], v[212:213], v[228:229]
    v_pk_add_f32 v[182:183], v[182:183], v[198:199]
    v_pk_add_f32 v[214:215], v[214:215], v[230:231]
    v_pk_add_f32 v[180:181], v[180:181], v[212:213]
    v_pk_add_f32 v[182:183], v[182:183], v[214:215]
    v_pk_mul_f32 v[44:45], v[180:181], s[12:13]
    v_pk_mul_f32 v[46:47], v[182:183], s[12:13]
    v_exp_f32 v44, v44
    v_exp_f32 v45, v45
    v_exp_f32 v46, v46
    v_exp_f32 v47, v47
    v_pk_mul_f32 v[180:181], v[180:181], v[244:245]
    v_pk_mul_f32 v[182:183], v[182:183], v[246:247]
    v_pk_add_f32 v[44:45], v[44:45], s[14:15]
    v_pk_add_f32 v[46:47], v[46:47], s[14:15]
    v_rcp_f32 v44, v44
    v_rcp_f32 v45, v45
    v_rcp_f32 v46, v46
    v_rcp_f32 v47, v47
    s_nop 0
    v_pk_fma_f32 v[180:181], v[180:181], v[44:45], v[24:25]
    v_pk_fma_f32 v[182:183], v[182:183], v[46:47], v[26:27]
    v_cvt_pk_bf16_f32 v180, v180, v181
    v_cvt_pk_bf16_f32 v182, v182, v183
    buffer_store_short v180, v9, s[28:31], s44 offen
    buffer_store_short_d16_hi v180, v9, s[28:31], s45 offen
    buffer_store_short v182, v9, s[28:31], s46 offen
    buffer_store_short_d16_hi v182, v9, s[28:31], s47 offen
    s_waitcnt lgkmcnt(3)
    v_pk_add_f32 v[184:185], v[184:185], v[200:201]
    v_pk_add_f32 v[216:217], v[216:217], v[232:233]
    v_pk_add_f32 v[186:187], v[186:187], v[202:203]
    v_pk_add_f32 v[218:219], v[218:219], v[234:235]
    v_pk_add_f32 v[184:185], v[184:185], v[216:217]
    v_pk_add_f32 v[186:187], v[186:187], v[218:219]
    v_pk_mul_f32 v[48:49], v[184:185], s[12:13]
    v_pk_mul_f32 v[50:51], v[186:187], s[12:13]
    v_exp_f32 v48, v48
    v_exp_f32 v49, v49
    v_exp_f32 v50, v50
    v_exp_f32 v51, v51
    v_pk_mul_f32 v[184:185], v[184:185], v[248:249]
    v_pk_mul_f32 v[186:187], v[186:187], v[250:251]
    v_pk_add_f32 v[48:49], v[48:49], s[14:15]
    v_pk_add_f32 v[50:51], v[50:51], s[14:15]
    v_rcp_f32 v48, v48
    v_rcp_f32 v49, v49
    v_rcp_f32 v50, v50
    v_rcp_f32 v51, v51
    s_nop 0
    v_pk_fma_f32 v[184:185], v[184:185], v[48:49], v[28:29]
    v_pk_fma_f32 v[186:187], v[186:187], v[50:51], v[30:31]
    v_cvt_pk_bf16_f32 v184, v184, v185
    v_cvt_pk_bf16_f32 v186, v186, v187
    buffer_store_short v184, v9, s[28:31], s48 offen
    buffer_store_short_d16_hi v184, v9, s[28:31], s49 offen
    buffer_store_short v186, v9, s[28:31], s50 offen
    buffer_store_short_d16_hi v186, v9, s[28:31], s51 offen
    s_waitcnt lgkmcnt(0)
    v_pk_add_f32 v[188:189], v[188:189], v[204:205]
    v_pk_add_f32 v[220:221], v[220:221], v[236:237]
    v_pk_add_f32 v[190:191], v[190:191], v[206:207]
    v_pk_add_f32 v[222:223], v[222:223], v[238:239]
    v_pk_add_f32 v[188:189], v[188:189], v[220:221]
    v_pk_add_f32 v[190:191], v[190:191], v[222:223]
    v_pk_mul_f32 v[52:53], v[188:189], s[12:13]
    v_pk_mul_f32 v[54:55], v[190:191], s[12:13]
    v_exp_f32 v52, v52
    v_exp_f32 v53, v53
    v_exp_f32 v54, v54
    v_exp_f32 v55, v55
    v_pk_mul_f32 v[188:189], v[188:189], v[252:253]
    v_pk_mul_f32 v[190:191], v[190:191], v[254:255]
    v_pk_add_f32 v[52:53], v[52:53], s[14:15]
    v_pk_add_f32 v[54:55], v[54:55], s[14:15]
    v_rcp_f32 v52, v52
    v_rcp_f32 v53, v53
    v_rcp_f32 v54, v54
    v_rcp_f32 v55, v55
    s_nop 0
    v_pk_fma_f32 v[188:189], v[188:189], v[52:53], v[32:33]
    v_pk_fma_f32 v[190:191], v[190:191], v[54:55], v[34:35]
    v_cvt_pk_bf16_f32 v188, v188, v189
    v_cvt_pk_bf16_f32 v190, v190, v191
    buffer_store_short v188, v9, s[28:31], s52 offen
    buffer_store_short_d16_hi v188, v9, s[28:31], s53 offen
    buffer_store_short v190, v9, s[28:31], s54 offen
    buffer_store_short_d16_hi v190, v9, s[28:31], s55 offen
K2_END:
    s_endpgm
.section .rodata,"a"
.p2align 6
.amdhsa_kernel recurrent_scan__spectral_fnet__glu_gated_reglu__prompt_kernel
  .amdhsa_next_free_vgpr 256
  .amdhsa_next_free_sgpr 102
  .amdhsa_accum_offset 256
  .amdhsa_group_segment_fixed_size 0
  .amdhsa_kernarg_size 96
  .amdhsa_user_sgpr_count 2
  .amdhsa_user_sgpr_kernarg_segment_ptr 1
  .amdhsa_system_sgpr_workgroup_id_x 1
.end_amdhsa_kernel
.section .rodata,"a"
.p2align 6
.amdhsa_kernel fnet_glu_combine_kernel
  .amdhsa_next_free_vgpr 416
  .amdhsa_next_free_sgpr 102
  .amdhsa_accum_offset 256
  .amdhsa_group_segment_fixed_size 0
  .amdhsa_kernarg_size 96
  .amdhsa_user_sgpr_count 2
  .amdhsa_user_sgpr_kernarg_segment_ptr 1
  .amdhsa_system_sgpr_workgroup_id_x 1
.end_amdhsa_kernel
```
